```python
import torch

def _softmax(x, axis=-1):
    return torch.softmax(x, dim=axis)
def _gelu(x):
    return torch.nn.functional.gelu(x, approximate="tanh")
def _silu(x):
    return torch.nn.functional.silu(x)
def _sigmoid(x):
    return torch.sigmoid(x)
def _layernorm(x, axis=-1, eps=1e-5):
    m = x.mean(dim=axis, keepdim=True)
    v = x.var(dim=axis, keepdim=True, unbiased=False)
    return (x - m) / torch.sqrt(v + eps)
def _scatter_add(tgt, idx, src, axis=0):
    return tgt.clone().index_add_(axis, idx, src)
def _segment_sum(src, seg, n):
    out = torch.zeros((n,) + src.shape[1:], dtype=src.dtype)
    return out.index_add_(0, seg, src)
def _pad(x, pw):
    flat = tuple(v for pair in reversed(pw) for v in pair)
    return torch.nn.functional.pad(x, flat)

kernel_name = 'interleave_layers__sliding_block_cached__glu_gated_glu__decode'

def setup_inputs():

    _w = (lambda a: (lambda t: t.to(torch.bfloat16) if t.is_floating_point() else t)(torch.as_tensor(a)))
    def _A_setup():
        B, Sq, D = 2, 1, 512
        Hq, Hkv, Sk, Dh = 32, 8, 32768, 128
        assert Hq % Hkv == 0, (Hq, Hkv)
        return {
            "x": _w((lambda *s: torch.randn(*s, dtype=torch.bfloat16) * 0.05)(B, Sq, D)),
            "k_cache": _w((lambda *s: torch.randn(*s, dtype=torch.bfloat16) * 1.6)(B, Hkv, Sk, Dh)),
            "v_cache": _w((lambda *s: torch.randn(*s, dtype=torch.bfloat16) * 1.6)(B, Hkv, Sk, Dh)),
            "wq": _w((lambda *s: torch.randn(*s, dtype=torch.bfloat16) * 1.6)(D, Hq * Dh) * (D ** -0.5)),
            "wo": _w((lambda *s: torch.randn(*s, dtype=torch.bfloat16) * 1.6)(Hq * Dh, D) * ((Hq * Dh) ** -0.5)),
        }
    _A_in = _A_setup()

    def _B_setup():
        B, S, D, F = 2, 1, 512, 1792
        return {
            "x": _w((lambda *s: torch.randn(*s, dtype=torch.bfloat16) * 0.05)(B, S, D)),
            "w_gate": _w((lambda *s: torch.randn(*s, dtype=torch.bfloat16) * 0.05)(D, F)),
            "w_up": _w((lambda *s: torch.randn(*s, dtype=torch.bfloat16) * 0.05)(D, F)),
            "w_down": _w((lambda *s: torch.randn(*s, dtype=torch.bfloat16) * 0.05)(F, D)),
        }
    _B_in = _B_setup()

    return {
        "A_x": _A_in["x"],
        "A_k_cache": _A_in["k_cache"],
        "A_v_cache": _A_in["v_cache"],
        "A_wq": _A_in["wq"],
        "A_wo": _A_in["wo"],
        "B_x": _B_in["x"],
        "B_w_gate": _B_in["w_gate"],
        "B_w_up": _B_in["w_up"],
        "B_w_down": _B_in["w_down"],
    }

def reference(A_x, A_k_cache, A_v_cache, A_wq, A_wo, B_x, B_w_gate, B_w_up, B_w_down):
    def _A_ref(x, k_cache, v_cache, wq, wo):
        B, Sq, D = x.shape
        Hq, Dh = 32, 128
        Hkv, Sk = k_cache.shape[1], k_cache.shape[2]
        W = min(4096, max(256, Sk // 4))
        rep = Hq // Hkv
        q = (lambda x, *d: x.permute(*d))((x @ wq).reshape(B, Sq, Hq, Dh), 0, 2, 1, 3)
        k = (lambda x, n, axis: torch.repeat_interleave(x, n, dim=axis))(k_cache[:, :, Sk - W:, :], rep, axis=1)
        v = (lambda x, n, axis: torch.repeat_interleave(x, n, dim=axis))(v_cache[:, :, Sk - W:, :], rep, axis=1)
        scores = torch.einsum("bhqd,bhkd->bhqk", q, k) * (Dh ** -0.5)
        p = _softmax(scores, axis=-1)
        o = torch.einsum("bhqk,bhkd->bhqd", p, v)
        return (lambda x, *d: x.permute(*d))(o, 0, 2, 1, 3).reshape(B, Sq, Hq * Dh) @ wo

    def _B_ref(x, w_gate, w_up, w_down):
        g = torch.einsum("bsd,df->bsf", x, w_gate)
        u = torch.einsum("bsd,df->bsf", x, w_up)
        h = _sigmoid(g) * u
        return torch.einsum("bsf,fd->bsd", h, w_down)

    x = A_x
    x = x + _A_ref(_layernorm(x, axis=-1), A_k_cache, A_v_cache, A_wq, A_wo)
    x = x + _B_ref(_layernorm(x, axis=-1), B_w_gate, B_w_up, B_w_down)
    x = x + _A_ref(_layernorm(x, axis=-1), A_k_cache, A_v_cache, A_wq, A_wo)
    x = x + _B_ref(_layernorm(x, axis=-1), B_w_gate, B_w_up, B_w_down)
    return x
```

```asm
; @launch grid=(256,1,1) block=(256,1,1) lds=163840
.amdgcn_target "amdgcn-amd-amdhsa--gfx950"
.text
.globl interleave_layers__sliding_block_cached__glu_gated_glu__decode_kernel
.p2align 8
.type interleave_layers__sliding_block_cached__glu_gated_glu__decode_kernel,@function
interleave_layers__sliding_block_cached__glu_gated_glu__decode_kernel:
    s_cmp_ge_u32 s2, 256
    s_cbranch_scc1 L_end
    s_load_dwordx4 s[76:79], s[0:1], 16
    s_load_dwordx4 s[72:75], s[0:1], 0
    s_load_dwordx2 s[88:89], s[0:1], 88
    s_load_dwordx2 s[70:71], s[0:1], 32
    s_load_dwordx4 s[80:83], s[0:1], 48
    s_load_dwordx4 s[84:87], s[0:1], 64
    v_lshrrev_b32 v4, 6, v0
    v_and_b32 v1, 63, v0
    s_getpc_b64 s[100:101]
L_pfbase:
    v_readfirstlane_b32 s5, v4
    v_lshlrev_b32 v5, 6, v0
    s_mov_b32 s61, (L_codeend - L_pfbase)
    v_cmp_gt_u32 vcc, s61, v5
    s_and_b32 s3, s2, 7
    s_and_saveexec_b64 s[58:59], vcc
    s_cbranch_execz L_nopf
    global_load_dword v159, v5, s[100:101]
L_nopf:
    s_mov_b64 exec, s[58:59]
    s_lshr_b32 s4, s2, 3
    v_lshrrev_b32 v6, 1, v1
    v_lshlrev_b32 v6, 13, v6
    v_and_b32 v7, 1, v1
    v_lshl_add_u32 v6, v7, 4, v6
    v_lshrrev_b32 v4, 3, v1
    v_lshlrev_b32 v4, 13, v4
    v_and_b32 v7, 7, v1
    v_lshl_add_u32 v4, v7, 7, v4
    s_lshl_b32 s62, s3, 10
    s_lshl_b32 s60, s4, 2
    s_add_u32 s60, s60, s5
    s_lshl_b32 s60, s60, 15
    s_add_u32 s60, s60, s62
    s_lshl_b32 s61, s5, 20
    s_add_u32 s61, s61, s62
    s_lshl_b32 s62, s4, 5
    s_add_u32 s61, s61, s62
    s_lshl_b32 s62, s5, 12
    s_add_u32 s62, s62, 147456
    s_mov_b32 s22, 0x400000
    s_mov_b32 s23, 0x20000
    s_waitcnt lgkmcnt(0)
    s_mov_b32 s20, s78
    s_and_b32 s21, s79, 0xffff
    s_mov_b32 exec_lo, 0xffffffff
    s_mov_b32 exec_hi, 0x0
    buffer_load_dword v132, v4, s[20:23], s60 offen
    s_mov_b64 exec, -1
    s_mov_b32 m0, s62
    s_add_u32 s62, s62, 1024
    buffer_load_dwordx4 v6, s[20:23], s61 offen nt lds
    s_add_u32 s61, s61, 262144
    s_mov_b32 m0, s62
    s_add_u32 s62, s62, 1024
    buffer_load_dwordx4 v6, s[20:23], s61 offen nt lds
    s_add_u32 s61, s61, 262144
    s_mov_b32 m0, s62
    s_add_u32 s62, s62, 1024
    buffer_load_dwordx4 v6, s[20:23], s61 offen nt lds
    s_add_u32 s61, s61, 262144
    s_mov_b32 m0, s62
    s_add_u32 s62, s62, 1024
    buffer_load_dwordx4 v6, s[20:23], s61 offen nt lds
    s_add_u32 s61, s61, 262144
    v_and_b32 v2, 15, v0
    v_lshrrev_b32 v3, 4, v1
    s_and_b32 s6, s4, 15
    s_and_b32 s65, s4, 7
    s_lshl_b32 s65, s65, 1
    s_lshr_b32 s61, s4, 4
    s_lshl_b32 s61, s61, 3
    s_add_u32 s61, s61, s3
    s_lshl_b32 s61, s61, 23
    s_lshl_b32 s62, s6, 16
    s_add_u32 s64, s61, s62
    s_add_u32 s64, s64, 0x700000
    v_lshlrev_b32 v5, 4, v1
    s_mov_b32 s12, s74
    s_and_b32 s13, s75, 0xffff
    s_mov_b32 s14, 0x8000000
    s_mov_b32 s15, 0x20000
    v_add_u32 v7, 0, v3
    v_xor_b32 v7, v7, v2
    v_lshlrev_b32 v7, 4, v7
    v_lshl_add_u32 v215, v3, 8, v7
    v_add_u32 v7, 4, v3
    v_xor_b32 v7, v7, v2
    v_lshlrev_b32 v7, 4, v7
    v_lshl_add_u32 v216, v3, 8, v7
    v_add_u32 v7, 8, v3
    v_xor_b32 v7, v7, v2
    v_lshlrev_b32 v7, 4, v7
    v_lshl_add_u32 v217, v3, 8, v7
    v_add_u32 v7, 12, v3
    v_xor_b32 v7, v7, v2
    v_lshlrev_b32 v7, 4, v7
    v_lshl_add_u32 v218, v3, 8, v7
    s_mov_b32 s8, s88
    s_and_b32 s9, s89, 0xffff
    s_mov_b32 s10, 0x1000000
    s_mov_b32 s11, 0x20000
    s_load_dword s44, s[88:89], 0
    s_mov_b32 s36, s72
    s_and_b32 s37, s73, 0xffff
    s_mov_b32 s38, 0x800
    s_mov_b32 s39, 0x20000
    s_cmp_eq_u32 s5, 0
    s_cbranch_scc0 L_nox0
    s_mov_b32 m0, 14336
    s_nop 0
    buffer_load_dwordx4 v5, s[36:39], 0 offen lds
    buffer_load_dwordx4 v5, s[36:39], 0 offen offset:1024 lds
L_nox0:
    s_mul_i32 s66, s3, 34816
    s_lshr_b32 s61, s4, 4
    s_lshl_b32 s61, s61, 14
    s_add_u32 s66, s66, s61
    s_lshl_b32 s61, s6, 4
    s_add_u32 s66, s66, s61
    s_add_u32 s66, s66, 262144
    s_lshl_b32 s62, s6, 10
    s_lshl_b32 s63, s3, 7
    s_add_u32 s62, s62, s63
    s_add_u32 s68, s62, 917504
    s_mov_b32 s69, 917504
    s_lshl_b32 s96, s3, 10
    s_add_u32 s96, s96, 163840
    s_lshl_b32 s97, s3, 11
    s_add_u32 s98, s97, 131072
    s_lshr_b32 s61, s4, 1
    s_and_b32 s61, s61, 3
    s_lshl_b32 s61, s61, 8
    s_add_u32 s97, s98, s61
    s_and_b32 s61, s4, 1
    s_lshl_b32 s61, s61, 7
    s_add_u32 s97, s97, s61
    s_lshr_b32 s61, s4, 3
    s_lshl_b32 s61, s61, 4
    s_add_u32 s97, s97, s61
    s_lshr_b32 s61, s4, 4
    s_lshl_b32 s61, s61, 10
    s_add_u32 s98, s98, s61
    v_mov_b32 v144, -1
    v_mov_b32 v145, -1
    v_mov_b32 v146, -1
    v_mov_b32 v147, -1
    v_bfe_u32 v7, v1, 1, 1
    v_lshlrev_b32 v7, 10, v7
    v_and_b32 v4, 1, v1
    v_lshl_add_u32 v7, v4, 6, v7
    v_add_u32 v4, s97, v7
    s_cmp_lt_u32 s4, 16
    s_cbranch_scc0 L_clr_B
    s_cmp_eq_u32 s5, 1
    s_cbranch_scc0 L_clr_A2
    s_mov_b64 exec, 15
    s_branch L_clr_st
L_clr_A2:
    s_cmp_eq_u32 s5, 2
    s_cbranch_scc0 L_clr_done
    s_xor_b32 s62, s68, 0x2000
    s_add_u32 s62, s62, 16384
    v_mov_b32 v4, s68
    v_mov_b32 v5, s62
    v_bfe_u32 v7, v1, 3, 1
    v_cmp_eq_u32 vcc, 1, v7
    s_nop 1
    v_cndmask_b32 v4, v4, v5, vcc
    v_lshrrev_b32 v7, 4, v1
    v_lshlrev_b32 v7, 15, v7
    v_and_b32 v5, 7, v1
    v_lshl_add_u32 v7, v5, 4, v7
    v_add_u32 v4, v4, v7
    s_branch L_clr_st
L_clr_B:
    s_cmp_eq_u32 s5, 2
    s_cbranch_scc0 L_clr_done
    s_mov_b64 exec, 15
    s_cmp_ge_u32 s6, 14
    s_cbranch_scc1 L_clr_st
    s_lshl_b32 s63, s6, 6
    s_add_u32 s62, s96, s63
    s_mov_b32 exec_lo, 0xff0
    s_mov_b32 exec_hi, 0x0
    v_bfe_u32 v7, v1, 3, 1
    v_lshlrev_b32 v7, 13, v7
    v_and_b32 v5, 3, v1
    v_lshl_add_u32 v7, v5, 4, v7
    v_add_u32 v4, s62, v7
    s_mov_b32 exec_lo, 0xfff
    s_mov_b32 exec_hi, 0x0
L_clr_st:
    buffer_store_dwordx4 v[144:147], v4, s[8:11], 0 offen sc1
    s_mov_b64 exec, -1
L_clr_done:
    s_add_u32 s63, s5, s65
    s_add_u32 s63, s63, 0
    s_and_b32 s63, s63, 15
    s_lshl_b32 s63, s63, 12
    s_add_u32 s63, s63, s64
    s_lshl_b32 s62, s5, 14
    s_add_u32 s62, s62, 16384
    s_mov_b32 m0, s62
    s_nop 0
    buffer_load_dwordx4 v215, s[12:15], s63 offen offset:0 nt lds
    buffer_load_dwordx4 v216, s[12:15], s63 offen offset:1024 nt lds
    buffer_load_dwordx4 v217, s[12:15], s63 offen offset:2048 nt lds
    buffer_load_dwordx4 v218, s[12:15], s63 offen offset:3072 nt lds
    s_mov_b32 s16, s76
    s_and_b32 s17, s77, 0xffff
    s_mov_b32 s18, 0x8000000
    s_mov_b32 s19, 0x20000
    s_mov_b32 s28, s82
    s_and_b32 s29, s83, 0xffff
    s_mov_b32 s30, 0x1c0000
    s_mov_b32 s31, 0x20000
    s_mov_b32 s32, s84
    s_and_b32 s33, s85, 0xffff
    s_mov_b32 s34, 0x1c0000
    s_mov_b32 s35, 0x20000
    s_mov_b32 s40, s86
    s_and_b32 s41, s87, 0xffff
    s_mov_b32 s42, 0x800
    s_mov_b32 s43, 0x20000
    s_cmp_lt_u32 s4, 16
    s_cselect_b32 s24, s70, s80
    s_cselect_b32 s25, s71, s81
    s_mov_b32 s26, 1835008
    s_cselect_b32 s26, 0x400000, s26
    s_and_b32 s25, s25, 0xffff
    s_mov_b32 s27, 0x20000
    s_mov_b32 s47, 400000
    s_getreg_b32 s99, hwreg(HW_REG_XCC_ID, 0, 4)
    s_mov_b32 s48, 0x00ff00ff
    s_mov_b32 s49, 0xff00ff00
    s_mov_b32 s50, 0x000f000f
    s_mov_b32 s51, 0x000f000f
    s_mov_b32 s52, 0x00030003
    s_mov_b32 s53, 0x00030003
    s_mov_b32 s54, 0x00020002
    s_mov_b32 s55, 0x00020002
    s_mov_b32 s56, 0x55555555
    s_mov_b32 s57, 0x55555555
    s_mov_b32 s7, 0
    s_mul_i32 s67, s3, 34816
    s_lshl_b32 s61, s5, 12
    s_add_u32 s67, s67, s61
    s_add_u32 s67, s67, 262144
    v_mov_b32 v8, 0x3f803f80
    v_mov_b32 v9, 0x3f803f80
    v_mov_b32 v10, 0x3f803f80
    v_mov_b32 v11, 0x3f803f80
    v_mov_b32 v12, 0
    v_mov_b32 v13, 0
    v_mov_b32 v14, 0
    v_mov_b32 v15, 0
    v_mov_b32 v16, 0
    v_mov_b32 v17, 0
    v_mov_b32 v18, 0
    v_mov_b32 v19, 0
    v_mov_b32 v20, 0
    v_mov_b32 v21, 0
    v_mov_b32 v22, 0
    v_mov_b32 v23, 0
    v_mov_b32 v24, 0
    v_mov_b32 v25, 0
    v_mov_b32 v26, 0
    v_mov_b32 v27, 0
    v_mov_b32 v136, 0
    v_mov_b32 v137, 0
    v_mov_b32 v138, 0
    v_mov_b32 v139, 0
    v_mov_b32 v140, 0
    v_mov_b32 v141, 0
    v_mov_b32 v142, 0
    v_mov_b32 v143, 0
    v_mov_b32 v180, 0
    v_mov_b32 v178, 0
    v_mov_b32 v179, 0
    v_and_b32 v144, 3, v2
    v_lshrrev_b32 v145, 1, v3
    v_and_b32 v146, 1, v3
    v_and_b32 v4, 7, v2
    v_lshlrev_b32 v4, 7, v4
    v_lshrrev_b32 v5, 3, v2
    v_lshl_add_u32 v4, v5, 6, v4
    v_lshl_add_u32 v188, v3, 4, v4
    v_lshrrev_b32 v4, 3, v1
    v_and_b32 v5, 2, v4
    v_and_b32 v6, 7, v1
    v_xor_b32 v5, v5, v6
    v_lshlrev_b32 v5, 4, v5
    v_lshl_add_u32 v4, v4, 7, v5
    s_lshl_b32 s61, s5, 12
    s_xor_b32 s62, s61, 0x2000
    s_add_u32 s62, s62, 16384
    s_lshr_b32 s60, s99, 2
    s_lshr_b32 s63, s5, 1
    s_cmp_eq_u32 s60, s63
    s_cselect_b32 s61, s61, s62
    v_add_u32 v189, s61, v4
    v_and_b32 v4, 7, v2
    v_lshrrev_b32 v5, 3, v2
    v_lshl_add_u32 v5, v5, 2, v3
    v_and_b32 v6, 2, v4
    v_xor_b32 v5, v5, v6
    v_lshlrev_b32 v5, 4, v5
    v_lshl_add_u32 v4, v4, 7, v5
    s_lshl_b32 s58, s5, 12
    s_add_u32 s58, s58, 81920
    v_add_u32 v190, s58, v4
    v_lshlrev_b32 v193, 4, v1
    v_add_u32 v194, 16384, v193
    v_lshl_add_u32 v4, v3, 2, v2
    v_and_b32 v4, 15, v4
    v_lshlrev_b32 v4, 4, v4
    s_mul_i32 s61, s5, 3840
    s_sub_u32 s61, 32768, s61
    v_add_u32 v195, s61, v4
    v_add_u32 v196, 1024, v195
    v_lshlrev_b32 v4, 6, v3
    v_lshl_add_u32 v197, v144, 4, v4
    v_lshlrev_b32 v4, 10, v146
    v_lshrrev_b32 v5, 3, v2
    v_lshl_add_u32 v4, v5, 6, v4
    v_and_b32 v5, 7, v2
    v_lshl_add_u32 v191, v5, 1, v4
    v_lshlrev_b32 v4, 12, v144
    v_lshl_add_u32 v4, v3, 10, v4
    v_bfe_u32 v5, v1, 2, 2
    v_lshl_add_u32 v192, v5, 8, v4
    v_and_b32 v4, 1, v2
    v_lshlrev_b32 v4, 5, v4
    v_lshl_add_u32 v4, v145, 6, v4
    v_lshl_add_u32 v4, v146, 4, v4
    s_lshl_b32 s61, s5, 7
    v_add_u32 v198, s61, v4
    v_lshlrev_b32 v4, 6, v3
    v_lshl_add_u32 v4, v144, 4, v4
    v_add_u32 v200, 256, v4
    v_lshrrev_b32 v5, 2, v2
    v_lshl_add_u32 v5, v5, 9, v200
    s_lshr_b32 s61, s5, 1
    s_lshl_b32 s61, s61, 8
    s_and_b32 s62, s5, 1
    s_lshl_b32 s62, s62, 3
    s_add_u32 s61, s61, s62
    v_add_u32 v199, s61, v5
    v_lshlrev_b32 v4, 4, v144
    v_add_u32 v201, 0, v4
    s_lshl_b32 s61, s5, 2
    v_add_u32 v202, s61, v201
    v_lshlrev_b32 v4, 4, v1
    v_add_u32 v203, s61, v4
    v_and_b32 v5, 1, v2
    v_lshl_add_u32 v5, v145, 1, v5
    v_lshlrev_b32 v5, 4, v5
    v_add_u32 v204, s61, v5
    v_lshl_add_u32 v4, v146, 5, v2
    v_lshlrev_b32 v205, 4, v4
    v_lshlrev_b32 v206, 5, v146
    v_lshlrev_b32 v4, 9, v146
    v_add_u32 v207, 256, v4
    v_lshlrev_b32 v208, 4, v1
    v_lshlrev_b32 v4, 5, v146
    v_lshl_add_u32 v209, v2, 1, v4
    v_lshlrev_b32 v4, 6, v146
    v_lshl_add_u32 v4, v145, 5, v4
    v_lshl_add_u32 v210, v2, 1, v4
    v_lshlrev_b32 v4, 12, v2
    v_lshl_add_u32 v4, v3, 8, v4
    s_lshl_b32 s61, s5, 10
    v_add_u32 v211, s61, v4
    s_lshr_b32 s61, s4, 4
    s_mul_i32 s61, s61, 15360
    s_sub_u32 s61, 32768, s61
    v_lshlrev_b32 v4, 8, v1
    v_add_u32 v212, s61, v4
    s_lshl_b32 s61, s5, 14
    s_add_u32 s61, s61, 16384
    v_add_u32 v4, 0, v3
    v_xor_b32 v4, v4, v2
    v_lshlrev_b32 v4, 4, v4
    v_lshl_add_u32 v4, v2, 8, v4
    v_add_u32 v223, s61, v4
    v_add_u32 v4, 4, v3
    v_xor_b32 v4, v4, v2
    v_lshlrev_b32 v4, 4, v4
    v_lshl_add_u32 v4, v2, 8, v4
    v_add_u32 v224, s61, v4
    v_add_u32 v4, 8, v3
    v_xor_b32 v4, v4, v2
    v_lshlrev_b32 v4, 4, v4
    v_lshl_add_u32 v4, v2, 8, v4
    v_add_u32 v225, s61, v4
    v_add_u32 v4, 12, v3
    v_xor_b32 v4, v4, v2
    v_lshlrev_b32 v4, 4, v4
    v_lshl_add_u32 v4, v2, 8, v4
    v_add_u32 v226, s61, v4
    v_add_u32 v5, 0, v3
    v_lshrrev_b32 v6, 1, v2
    v_xor_b32 v5, v5, v6
    v_lshlrev_b32 v5, 1, v5
    v_and_b32 v6, 1, v2
    v_or_b32 v5, v5, v6
    v_lshlrev_b32 v5, 4, v5
    v_lshl_add_u32 v219, v3, 8, v5
    v_add_u32 v5, 4, v3
    v_lshrrev_b32 v6, 1, v2
    v_xor_b32 v5, v5, v6
    v_lshlrev_b32 v5, 1, v5
    v_and_b32 v6, 1, v2
    v_or_b32 v5, v5, v6
    v_lshlrev_b32 v5, 4, v5
    v_lshl_add_u32 v220, v3, 8, v5
    v_lshrrev_b32 v5, 2, v2
    v_lshl_add_u32 v4, v3, 2, v5
    v_and_b32 v6, 7, v4
    s_lshl_b32 s61, s5, 1
    s_add_u32 s61, s61, 0
    v_xor_b32 v6, s61, v6
    v_lshlrev_b32 v6, 5, v6
    v_lshl_add_u32 v4, v4, 8, v6
    v_lshl_add_u32 v4, v144, 3, v4
    v_add_u32 v221, 81920, v4
    v_lshrrev_b32 v5, 2, v2
    v_lshl_add_u32 v4, v3, 2, v5
    v_and_b32 v6, 7, v4
    s_lshl_b32 s61, s5, 1
    s_add_u32 s61, s61, 1
    v_xor_b32 v6, s61, v6
    v_lshlrev_b32 v6, 5, v6
    v_lshl_add_u32 v4, v4, 8, v6
    v_lshl_add_u32 v4, v144, 3, v4
    v_add_u32 v222, 81920, v4
    v_mov_b32 v36, 0
    v_mov_b32 v37, 0
    v_mov_b32 v38, 0
    v_mov_b32 v39, 0
    v_mov_b32 v40, 0
    v_mov_b32 v41, 0
    v_mov_b32 v42, 0
    v_mov_b32 v43, 0
    v_mov_b32 v44, 0
    v_mov_b32 v45, 0
    v_mov_b32 v46, 0
    v_mov_b32 v47, 0
    v_mov_b32 v48, 0
    v_mov_b32 v49, 0
    v_mov_b32 v50, 0
    v_mov_b32 v51, 0
    s_waitcnt vmcnt(4)
    s_add_u32 s63, s5, s65
    s_add_u32 s63, s63, 4
    s_and_b32 s63, s63, 15
    s_lshl_b32 s63, s63, 12
    s_add_u32 s63, s63, s64
    s_lshl_b32 s62, s5, 14
    s_add_u32 s62, s62, 20480
    s_mov_b32 m0, s62
    s_nop 0
    buffer_load_dwordx4 v215, s[12:15], s63 offen offset:0 nt lds
    buffer_load_dwordx4 v216, s[12:15], s63 offen offset:1024 nt lds
    buffer_load_dwordx4 v217, s[12:15], s63 offen offset:2048 nt lds
    buffer_load_dwordx4 v218, s[12:15], s63 offen offset:3072 nt lds
    s_lshl_b32 s61, s5, 12
    v_lshrrev_b32 v5, 2, v2
    v_lshl_add_u32 v5, v3, 3, v5
    v_lshlrev_b32 v5, 5, v5
    v_and_b32 v6, 3, v2
    v_lshl_add_u32 v5, v6, 3, v5
    v_add_u32 v5, s61, v5
    v_add_u32 v4, 147456, v5
    ds_read_b64_tr_b16 a[128:129], v4 offset:0
    ds_read_b64_tr_b16 a[130:131], v4 offset:128
    ds_read_b64_tr_b16 a[132:133], v4 offset:1024
    ds_read_b64_tr_b16 a[134:135], v4 offset:1152
    ds_read_b64_tr_b16 a[136:137], v4 offset:2048
    ds_read_b64_tr_b16 a[138:139], v4 offset:2176
    ds_read_b64_tr_b16 a[140:141], v4 offset:3072
    ds_read_b64_tr_b16 a[142:143], v4 offset:3200
    v_lshrrev_b32 v4, 3, v2
    v_lshlrev_b32 v4, 10, v4
    v_lshl_add_u32 v4, v3, 4, v4
    s_lshl_b32 s61, s5, 8
    v_add_u32 v4, s61, v4
    s_barrier
    s_mov_b32 exec_lo, 0x1010101
    s_mov_b32 exec_hi, 0x1010101
    ds_read_b128 v[36:39], v4 offset:14336
    ds_read_b128 v[40:43], v4 offset:14400
    ds_read_b128 v[44:47], v4 offset:14464
    ds_read_b128 v[48:51], v4 offset:14528
    s_mov_b64 exec, -1
    s_waitcnt lgkmcnt(0)
    s_add_u32 s44, s44, 0x9e3779b0
    s_and_b32 s44, s44, 0xfffffff0
    s_or_b32 s45, s44, s99
    v_mfma_f32_16x16x32_bf16 v[84:87], v[8:11], a[128:131], 0
    v_mfma_f32_16x16x32_bf16 v[84:87], v[8:11], a[132:135], v[84:87]
    v_mfma_f32_16x16x32_bf16 v[84:87], v[8:11], a[136:139], v[84:87]
    v_mfma_f32_16x16x32_bf16 v[84:87], v[8:11], a[140:143], v[84:87]
    s_nop 7
    ds_write_b32 v203, v84 offset:7680
    v_mfma_f32_16x16x32_bf16 v[76:79], v[36:39], v[36:39], 0
    v_mfma_f32_16x16x32_bf16 v[76:79], v[40:43], v[40:43], v[76:79]
    v_mfma_f32_16x16x32_bf16 v[76:79], v[44:47], v[44:47], v[76:79]
    v_mfma_f32_16x16x32_bf16 v[76:79], v[48:51], v[48:51], v[76:79]
    v_mfma_f32_16x16x32_bf16 v[80:83], v[36:39], v[8:11], 0
    v_mfma_f32_16x16x32_bf16 v[80:83], v[40:43], v[8:11], v[80:83]
    v_mfma_f32_16x16x32_bf16 v[80:83], v[44:47], v[8:11], v[80:83]
    v_mfma_f32_16x16x32_bf16 v[80:83], v[48:51], v[8:11], v[80:83]
    v_mfma_f32_16x16x32_bf16 v[68:71], v[36:39], a[128:131], 0
    s_nop 2
    v_add_f32 v144, v76, v77
    v_add_f32 v7, v78, v79
    v_mfma_f32_16x16x32_bf16 v[68:71], v[40:43], a[132:135], v[68:71]
    v_add_f32 v144, v144, v7
    v_cndmask_b32 v144, 0, v144, s[48:49]
    v_mfma_f32_16x16x32_bf16 v[68:71], v[44:47], a[136:139], v[68:71]
    s_nop 0
    v_add_f32_dpp v144, v144, v144 row_ror:8 row_mask:0xf bank_mask:0xf
    s_nop 1
    v_add_f32_dpp v144, v144, v144 row_ror:4 row_mask:0xf bank_mask:0xf
    v_mfma_f32_16x16x32_bf16 v[68:71], v[48:51], a[140:143], v[68:71]
    s_nop 0
    v_add_f32_dpp v144, v144, v144 row_ror:2 row_mask:0xf bank_mask:0xf
    s_nop 1
    v_add_f32_dpp v144, v144, v144 row_ror:1 row_mask:0xf bank_mask:0xf
    v_add_f32 v145, v80, v81
    v_add_f32 v7, v82, v83
    v_add_f32 v145, v145, v7
    v_cndmask_b32 v144, v145, v144, s[54:55]
    v_add_f32 v146, v68, v69
    v_add_f32 v7, v70, v71
    v_add_f32 v146, v146, v7
    s_nop 1
    v_permlane16_swap_b32 v146, v144
    v_add_f32 v144, v144, v146
    ds_write_b32 v203, v144 offset:2560
    s_waitcnt lgkmcnt(0)
    s_barrier
    s_cmp_eq_u32 s5, 0
    s_cbranch_scc0 qf_1
    s_mov_b32 exec_lo, 0xffffffff
    s_mov_b32 exec_hi, 0x0
    ds_read_b128 v[144:147], v205 offset:2560
    ds_read_b128 v[148:151], v207 offset:2560
    ds_read_b128 v[152:155], v207 offset:2576
    ds_read_b128 v[156:159], v205 offset:7680
    s_waitcnt lgkmcnt(0)
    v_add_f32 v156, v156, v157
    v_add_f32 v158, v158, v159
    v_add_f32 v156, v156, v158
    v_mov_b32 v170, v156
    v_add_f32 v148, v148, v149
    v_add_f32 v150, v150, v151
    v_add_f32 v148, v148, v150
    v_add_f32 v152, v152, v153
    v_add_f32 v154, v154, v155
    v_add_f32 v152, v152, v154
    v_add_f32 v144, v144, v145
    v_add_f32 v146, v146, v147
    v_add_f32 v144, v144, v146
    v_mul_f32 v149, 0x3b000000, v148
    v_mul_f32 v152, 0x3b000000, v152
    v_fma_f32 v152, -v149, v149, v152
    v_max_f32 v152, 0, v152
    v_add_f32 v152, 0x3727c5ac, v152
    v_rsq_f32 v150, v152
    v_fma_f32 v144, -v149, v170, v144
    v_mul_f32 v144, v144, v150
    s_nop 1
    v_mov_b32_dpp v145, v144 quad_perm:[1,0,3,2] row_mask:0xf bank_mask:0xf
    v_cvt_pk_bf16_f32 v146, v144, v145
    v_mov_b32 v178, v146
    v_mov_b32 v179, s45
    s_lshl_b32 s61, s3, 12
    s_lshl_b32 s62, s4, 7
    s_add_u32 s61, s61, s62
    s_add_u32 s61, s61, 65536
    v_lshlrev_b32 v4, 1, v209
    v_add_u32 v180, s61, v4
    s_mov_b32 exec_lo, 0x55555555
    s_mov_b32 exec_hi, 0x0
    buffer_store_dwordx2 v[178:179], v180, s[8:11], 0 offen
    s_mov_b64 exec, -1
qf_1:
    s_barrier
    s_waitcnt vmcnt(8)
    s_add_u32 s63, s5, s65
    s_add_u32 s63, s63, 8
    s_and_b32 s63, s63, 15
    s_lshl_b32 s63, s63, 12
    s_add_u32 s63, s63, s64
    s_lshl_b32 s62, s5, 14
    s_add_u32 s62, s62, 24576
    s_mov_b32 m0, s62
    s_nop 0
    buffer_load_dwordx4 v215, s[12:15], s63 offen offset:0 nt lds
    buffer_load_dwordx4 v216, s[12:15], s63 offen offset:1024 nt lds
    buffer_load_dwordx4 v217, s[12:15], s63 offen offset:2048 nt lds
    buffer_load_dwordx4 v218, s[12:15], s63 offen offset:3072 nt lds
    s_waitcnt vmcnt(8)
    s_add_u32 s63, s5, s65
    s_add_u32 s63, s63, 12
    s_and_b32 s63, s63, 15
    s_lshl_b32 s63, s63, 12
    s_add_u32 s63, s63, s64
    s_lshl_b32 s62, s5, 14
    s_add_u32 s62, s62, 28672
    s_mov_b32 m0, s62
    s_nop 0
    buffer_load_dwordx4 v215, s[12:15], s63 offen offset:0 nt lds
    buffer_load_dwordx4 v216, s[12:15], s63 offen offset:1024 nt lds
    buffer_load_dwordx4 v217, s[12:15], s63 offen offset:2048 nt lds
    buffer_load_dwordx4 v218, s[12:15], s63 offen offset:3072 nt lds
    v_lshrrev_b32 v4, 2, v1
    v_lshlrev_b32 v4, 7, v4
    v_and_b32 v5, 3, v1
    v_lshl_add_u32 v215, v5, 4, v4
    s_lshl_b32 s60, s3, 12
    s_lshr_b32 s61, s4, 4
    s_lshl_b32 s61, s61, 6
    s_add_u32 s60, s60, s61
    s_add_u32 s60, s60, 65536
    v_and_b32 v4, 3, v2
    v_lshlrev_b32 v4, 9, v4
    v_lshrrev_b32 v5, 1, v3
    v_lshl_add_u32 v4, v5, 6, v4
    v_and_b32 v5, 1, v3
    v_lshl_add_u32 v216, v5, 5, v4
    v_lshlrev_b32 v217, 5, v1
    s_mov_b32 s59, 0
    s_cmp_eq_u32 s5, 0
    s_cbranch_scc0 w0_2
    s_mov_b32 m0, 14336
    s_add_u32 s61, s60, 2048
    buffer_load_dwordx4 v215, s[8:11], s60 offen sc1 lds
    s_mov_b32 m0, 15360
    s_nop 0
    buffer_load_dwordx4 v215, s[8:11], s61 offen sc1 lds
w0_2:
    s_waitcnt vmcnt(8)
    s_add_u32 s63, s5, s65
    s_add_u32 s63, s63, 0
    s_and_b32 s63, s63, 15
    s_lshl_b32 s63, s63, 12
    s_add_u32 s63, s63, s64
    s_lshl_b32 s62, s5, 12
    s_add_u32 s62, s62, 81920
    s_mov_b32 m0, s62
    s_nop 0
    buffer_load_dwordx4 v219, s[16:19], s63 offen offset:0 nt lds
    buffer_load_dwordx4 v220, s[16:19], s63 offen offset:1024 nt lds
    buffer_load_dwordx4 v219, s[16:19], s63 offen offset:2048 nt lds
    buffer_load_dwordx4 v220, s[16:19], s63 offen offset:3072 nt lds
    s_waitcnt vmcnt(4)
    ds_read_b128 a[0:3], v223 offset:0
    ds_read_b128 a[4:7], v224 offset:0
    ds_read_b128 a[8:11], v225 offset:0
    ds_read_b128 a[12:15], v226 offset:0
    ds_read_b128 a[16:19], v223 offset:4096
    ds_read_b128 a[20:23], v224 offset:4096
    ds_read_b128 a[24:27], v225 offset:4096
    ds_read_b128 a[28:31], v226 offset:4096
    ds_read_b128 a[32:35], v223 offset:8192
    ds_read_b128 a[36:39], v224 offset:8192
    ds_read_b128 a[40:43], v225 offset:8192
    ds_read_b128 a[44:47], v226 offset:8192
    ds_read_b128 a[48:51], v223 offset:12288
    ds_read_b128 a[52:55], v224 offset:12288
    ds_read_b128 a[56:59], v225 offset:12288
    ds_read_b128 a[60:63], v226 offset:12288
    s_barrier
    ds_read_b128 v[28:31], v217 offset:14336
    ds_read_b128 v[32:35], v217 offset:14352
    s_waitcnt lgkmcnt(0)
    v_xor_b32 v5, s45, v29
    v_xor_b32 v6, s45, v31
    v_xor_b32 v7, s45, v33
    v_xor_b32 v4, s45, v35
    v_or3_b32 v5, v5, v6, v7
    v_or_b32 v5, v5, v4
    v_cmp_lt_u32 vcc, 15, v5
    s_cbranch_vccnz L_noearly
    v_cmp_ne_u32 vcc, 0, v5
    s_nop 0
    s_cmp_eq_u64 vcc, 0
    s_cselect_b32 s46, 1, 0
    s_mov_b32 s59, 1
    s_add_u32 s63, s5, s65
    s_add_u32 s63, s63, 4
    s_and_b32 s63, s63, 15
    s_lshl_b32 s63, s63, 12
    s_add_u32 s63, s63, s64
    s_lshl_b32 s62, s5, 12
    s_add_u32 s62, s62, 98304
    s_mov_b32 m0, s62
    s_nop 0
    buffer_load_dwordx4 v219, s[16:19], s63 offen offset:0 nt lds
    buffer_load_dwordx4 v220, s[16:19], s63 offen offset:1024 nt lds
    buffer_load_dwordx4 v219, s[16:19], s63 offen offset:2048 nt lds
    buffer_load_dwordx4 v220, s[16:19], s63 offen offset:3072 nt lds
    s_mov_b32 s62, 14336
    s_branch L_q1ok2
L_noearly:
    s_cmp_eq_u32 s5, 0
    s_cbranch_scc0 w0_3
    s_mov_b32 m0, 10240
    s_add_u32 s61, s60, 2048
    buffer_load_dwordx4 v215, s[8:11], s60 offen sc1 lds
    s_mov_b32 m0, 11264
    s_nop 0
    buffer_load_dwordx4 v215, s[8:11], s61 offen sc1 lds
w0_3:
    s_add_u32 s63, s5, s65
    s_add_u32 s63, s63, 4
    s_and_b32 s63, s63, 15
    s_lshl_b32 s63, s63, 12
    s_add_u32 s63, s63, s64
    s_lshl_b32 s62, s5, 12
    s_add_u32 s62, s62, 98304
    s_mov_b32 m0, s62
    s_nop 0
    buffer_load_dwordx4 v219, s[16:19], s63 offen offset:0 nt lds
    buffer_load_dwordx4 v220, s[16:19], s63 offen offset:1024 nt lds
    buffer_load_dwordx4 v219, s[16:19], s63 offen offset:2048 nt lds
    buffer_load_dwordx4 v220, s[16:19], s63 offen offset:3072 nt lds
    s_waitcnt vmcnt(4)
    s_lshl_b32 s63, s4, 2
    s_add_u32 s63, s63, s5
    s_load_dwordx2 s[12:13], s[0:1], 32
    s_load_dwordx2 s[20:21], s[0:1], 48
    s_waitcnt lgkmcnt(0)
    s_and_b32 s13, s13, 0xffff
    s_mov_b32 s14, 0x400000
    s_and_b32 s21, s21, 0xffff
    s_mov_b32 s22, 1835008
    v_lshlrev_b32 v4, 7, v1
    s_lshl_b32 s61, s3, 19
    s_lshl_b32 s62, s63, 12
    s_add_u32 s61, s61, s62
    s_mov_b32 exec_lo, 0xffffffff
    s_mov_b32 exec_hi, 0x0
    buffer_load_dword v132, v4, s[12:15], s61 offen
    s_mov_b64 exec, -1
    s_add_u32 s63, s5, s65
    s_add_u32 s63, s63, 8
    s_and_b32 s63, s63, 15
    s_lshl_b32 s63, s63, 12
    s_add_u32 s63, s63, s64
    s_lshl_b32 s62, s5, 12
    s_add_u32 s62, s62, 114688
    s_mov_b32 m0, s62
    s_nop 0
    buffer_load_dwordx4 v219, s[16:19], s63 offen offset:0 nt lds
    buffer_load_dwordx4 v220, s[16:19], s63 offen offset:1024 nt lds
    buffer_load_dwordx4 v219, s[16:19], s63 offen offset:2048 nt lds
    buffer_load_dwordx4 v220, s[16:19], s63 offen offset:3072 nt lds
    s_barrier
    ds_read_b128 v[28:31], v217 offset:10240
    ds_read_b128 v[32:35], v217 offset:10256
    s_waitcnt lgkmcnt(0)
    v_xor_b32 v5, s45, v29
    v_xor_b32 v6, s45, v31
    v_xor_b32 v7, s45, v33
    v_xor_b32 v4, s45, v35
    v_or3_b32 v5, v5, v6, v7
    v_or_b32 v5, v5, v4
    v_cmp_lt_u32 vcc, 15, v5
    s_mov_b32 s62, 10240
    s_cbranch_vccz L_q1ok
    s_cmp_eq_u32 s5, 0
    s_cbranch_scc0 w0_4
    s_mov_b32 m0, 12288
    s_add_u32 s61, s60, 2048
    buffer_load_dwordx4 v215, s[8:11], s60 offen sc1 lds
    s_mov_b32 m0, 13312
    s_nop 0
    buffer_load_dwordx4 v215, s[8:11], s61 offen sc1 lds
    s_waitcnt vmcnt(0)
w0_4:
    s_barrier
    ds_read_b128 v[28:31], v217 offset:12288
    ds_read_b128 v[32:35], v217 offset:12304
    s_waitcnt lgkmcnt(0)
    v_xor_b32 v5, s45, v29
    v_xor_b32 v6, s45, v31
    v_xor_b32 v7, s45, v33
    v_xor_b32 v4, s45, v35
    v_or3_b32 v5, v5, v6, v7
    v_or_b32 v5, v5, v4
    v_cmp_lt_u32 vcc, 15, v5
    s_mov_b32 s62, 12288
    s_cbranch_vccz L_q1ok
L_q1retry:
    s_sub_u32 s47, s47, 1
    s_cbranch_scc1 L_abort
    s_barrier
    s_cmp_eq_u32 s5, 0
    s_cbranch_scc0 w0_5
    s_mov_b32 exec_lo, 0x55555555
    s_mov_b32 exec_hi, 0x0
    buffer_store_dwordx2 v[178:179], v180, s[8:11], 0 offen sc1
    s_mov_b64 exec, -1
    s_mov_b32 m0, 10240
    s_add_u32 s61, s60, 2048
    buffer_load_dwordx4 v215, s[8:11], s60 offen sc1 lds
    s_mov_b32 m0, 11264
    s_nop 0
    buffer_load_dwordx4 v215, s[8:11], s61 offen sc1 lds
    s_waitcnt vmcnt(0)
w0_5:
    s_barrier
    ds_read_b128 v[28:31], v217 offset:10240
    ds_read_b128 v[32:35], v217 offset:10256
    s_waitcnt lgkmcnt(0)
    v_xor_b32 v5, s45, v29
    v_xor_b32 v6, s45, v31
    v_xor_b32 v7, s45, v33
    v_xor_b32 v4, s45, v35
    v_or3_b32 v5, v5, v6, v7
    v_or_b32 v5, v5, v4
    v_cmp_lt_u32 vcc, 15, v5
    s_mov_b32 s62, 10240
    s_cbranch_vccnz L_q1retry
L_q1ok:
    v_cmp_ne_u32 vcc, 0, v5
    s_nop 0
    s_cmp_eq_u64 vcc, 0
    s_cselect_b32 s46, 1, 0
L_q1ok2:
    v_add_u32 v4, s62, v216
    s_mov_b64 exec, s[50:51]
    ds_read2_b32 v[12:13], v4 offset0:0 offset1:2
    ds_read2_b32 v[14:15], v4 offset0:4 offset1:6
    ds_read2_b32 v[16:17], v4 offset0:32 offset1:34
    ds_read2_b32 v[18:19], v4 offset0:36 offset1:38
    ds_read2_b32 v[20:21], v4 offset0:64 offset1:66
    ds_read2_b32 v[22:23], v4 offset0:68 offset1:70
    ds_read2_b32 v[24:25], v4 offset0:96 offset1:98
    ds_read2_b32 v[26:27], v4 offset0:100 offset1:102
    s_mov_b64 exec, -1
    s_cmp_eq_u32 s46, 0
    s_cbranch_scc0 nl_6
    s_cmp_eq_u32 s5, 0
    s_cbranch_scc0 w0_7
    s_mov_b32 exec_lo, 0x55555555
    s_mov_b32 exec_hi, 0x0
    buffer_store_dwordx2 v[178:179], v180, s[8:11], 0 offen sc1
    s_mov_b64 exec, -1
w0_7:
nl_6:
    s_waitcnt lgkmcnt(0)
    v_mfma_f32_16x16x32_bf16 v[84:87], a[0:3], v[12:15], 0
    v_mfma_f32_16x16x32_bf16 v[88:91], a[16:19], v[12:15], 0
    v_mfma_f32_16x16x32_bf16 v[92:95], a[32:35], v[12:15], 0
    v_mfma_f32_16x16x32_bf16 v[96:99], a[48:51], v[12:15], 0
    v_mfma_f32_16x16x32_bf16 v[84:87], a[4:7], v[16:19], v[84:87]
    v_mfma_f32_16x16x32_bf16 v[88:91], a[20:23], v[16:19], v[88:91]
    v_mfma_f32_16x16x32_bf16 v[92:95], a[36:39], v[16:19], v[92:95]
    v_mfma_f32_16x16x32_bf16 v[96:99], a[52:55], v[16:19], v[96:99]
    v_mfma_f32_16x16x32_bf16 v[84:87], a[8:11], v[20:23], v[84:87]
    v_mfma_f32_16x16x32_bf16 v[88:91], a[24:27], v[20:23], v[88:91]
    v_mfma_f32_16x16x32_bf16 v[92:95], a[40:43], v[20:23], v[92:95]
    v_mfma_f32_16x16x32_bf16 v[96:99], a[56:59], v[20:23], v[96:99]
    v_mfma_f32_16x16x32_bf16 v[84:87], a[12:15], v[24:27], v[84:87]
    v_mfma_f32_16x16x32_bf16 v[88:91], a[28:31], v[24:27], v[88:91]
    v_mfma_f32_16x16x32_bf16 v[92:95], a[44:47], v[24:27], v[92:95]
    v_mfma_f32_16x16x32_bf16 v[96:99], a[60:63], v[24:27], v[96:99]
    s_nop 5
    v_mov_b32_dpp v84, v88 row_shr:4 row_mask:0xf bank_mask:0x2
    v_mov_b32_dpp v85, v89 row_shr:4 row_mask:0xf bank_mask:0x2
    v_mov_b32_dpp v86, v90 row_shr:4 row_mask:0xf bank_mask:0x2
    v_mov_b32_dpp v87, v91 row_shr:4 row_mask:0xf bank_mask:0x2
    v_mov_b32_dpp v84, v92 row_shr:8 row_mask:0xf bank_mask:0x4
    v_mov_b32_dpp v85, v93 row_shr:8 row_mask:0xf bank_mask:0x4
    v_mov_b32_dpp v86, v94 row_shr:8 row_mask:0xf bank_mask:0x4
    v_mov_b32_dpp v87, v95 row_shr:8 row_mask:0xf bank_mask:0x4
    v_mov_b32_dpp v84, v96 row_shr:12 row_mask:0xf bank_mask:0x8
    v_mov_b32_dpp v85, v97 row_shr:12 row_mask:0xf bank_mask:0x8
    v_mov_b32_dpp v86, v98 row_shr:12 row_mask:0xf bank_mask:0x8
    v_mov_b32_dpp v87, v99 row_shr:12 row_mask:0xf bank_mask:0x8
    v_max3_f32 v144, v84, v85, v86
    v_max_f32 v144, v144, v87
    s_nop 1
    v_max_f32_dpp v144, v144, v144 row_ror:8 row_mask:0xf bank_mask:0xf
    s_nop 1
    v_max_f32_dpp v144, v144, v144 row_ror:4 row_mask:0xf bank_mask:0xf
    v_mov_b32 v4, v144
    s_nop 1
    v_permlane32_swap_b32 v144, v4
    v_max_f32 v144, v144, v4
    v_mov_b32 v4, v144
    s_nop 1
    v_permlane16_swap_b32 v144, v4
    v_max_f32 v144, v144, v4
    s_mov_b64 exec, 15
    ds_write_b32 v202, v144
    s_mov_b64 exec, -1
    s_waitcnt lgkmcnt(0)
    s_barrier
    s_cmp_eq_u32 s59, 1
    s_cbranch_scc1 mE_8
    s_waitcnt vmcnt(4)
    s_cmp_eq_u32 s5, 3
    s_cbranch_scc0 c0_10
    v_mov_b32 v152, -1
    v_mov_b32 v153, -1
    v_mov_b32 v154, -1
    v_mov_b32 v155, -1
    s_cmp_eq_u32 s46, 0
    s_cbranch_scc1 stg_11
    buffer_store_dwordx4 v[152:155], v192, s[8:11], s66 offen
std_12:
c0_10:
    s_cmp_lt_u32 s4, 16
    s_cbranch_scc0 ws_13
    buffer_load_dword v132, v195, s[8:11], s67 offen sc1
    buffer_load_dword v132, v196, s[8:11], s67 offen sc1
ws_13:
    s_add_u32 s63, s5, s65
    s_add_u32 s63, s63, 12
    s_and_b32 s63, s63, 15
    s_lshl_b32 s63, s63, 12
    s_add_u32 s63, s63, s64
    s_lshl_b32 s62, s5, 12
    s_add_u32 s62, s62, 131072
    s_mov_b32 m0, s62
    s_nop 0
    buffer_load_dwordx4 v219, s[16:19], s63 offen offset:0 nt lds
    buffer_load_dwordx4 v220, s[16:19], s63 offen offset:1024 nt lds
    buffer_load_dwordx4 v219, s[16:19], s63 offen offset:2048 nt lds
    buffer_load_dwordx4 v220, s[16:19], s63 offen offset:3072 nt lds
    s_branch mD_9
mE_8:
    s_waitcnt vmcnt(4)
    s_cmp_eq_u32 s5, 3
    s_cbranch_scc0 c0_14
    v_mov_b32 v152, -1
    v_mov_b32 v153, -1
    v_mov_b32 v154, -1
    v_mov_b32 v155, -1
    s_cmp_eq_u32 s46, 0
    s_cbranch_scc1 stg_15
    buffer_store_dwordx4 v[152:155], v192, s[8:11], s66 offen
std_16:
c0_14:
    s_cmp_lt_u32 s4, 16
    s_cbranch_scc0 ws_17
    buffer_load_dword v132, v195, s[8:11], s67 offen sc1
    buffer_load_dword v132, v196, s[8:11], s67 offen sc1
ws_17:
    s_lshl_b32 s63, s4, 2
    s_add_u32 s63, s63, s5
    s_load_dwordx2 s[12:13], s[0:1], 32
    s_load_dwordx2 s[20:21], s[0:1], 48
    s_waitcnt lgkmcnt(0)
    s_and_b32 s13, s13, 0xffff
    s_mov_b32 s14, 0x400000
    s_and_b32 s21, s21, 0xffff
    s_mov_b32 s22, 1835008
    v_lshlrev_b32 v4, 7, v1
    s_lshl_b32 s61, s3, 19
    s_lshl_b32 s62, s63, 12
    s_add_u32 s61, s61, s62
    s_mov_b32 exec_lo, 0xffffffff
    s_mov_b32 exec_hi, 0x0
    buffer_load_dword v132, v4, s[12:15], s61 offen
    s_mov_b64 exec, -1
    s_add_u32 s63, s5, s65
    s_add_u32 s63, s63, 8
    s_and_b32 s63, s63, 15
    s_lshl_b32 s63, s63, 12
    s_add_u32 s63, s63, s64
    s_lshl_b32 s62, s5, 12
    s_add_u32 s62, s62, 114688
    s_mov_b32 m0, s62
    s_nop 0
    buffer_load_dwordx4 v219, s[16:19], s63 offen offset:0 nt lds
    buffer_load_dwordx4 v220, s[16:19], s63 offen offset:1024 nt lds
    buffer_load_dwordx4 v219, s[16:19], s63 offen offset:2048 nt lds
    buffer_load_dwordx4 v220, s[16:19], s63 offen offset:3072 nt lds
    s_add_u32 s63, s5, s65
    s_add_u32 s63, s63, 12
    s_and_b32 s63, s63, 15
    s_lshl_b32 s63, s63, 12
    s_add_u32 s63, s63, s64
    s_lshl_b32 s62, s5, 12
    s_add_u32 s62, s62, 131072
    s_mov_b32 m0, s62
    s_nop 0
    buffer_load_dwordx4 v219, s[16:19], s63 offen offset:0 nt lds
    buffer_load_dwordx4 v220, s[16:19], s63 offen offset:1024 nt lds
    buffer_load_dwordx4 v219, s[16:19], s63 offen offset:2048 nt lds
    buffer_load_dwordx4 v220, s[16:19], s63 offen offset:3072 nt lds
    s_waitcnt vmcnt(8)
mD_9:
    s_cmp_lt_u32 s4, 16
    s_cbranch_scc0 L_roleB
    ds_read_b128 v[148:151], v201
    s_mov_b32 s61, 0x3e0293ee
    s_waitcnt lgkmcnt(0)
    v_max3_f32 v144, v148, v149, v150
    v_max_f32 v144, v144, v151
    v_mul_f32 v184, s61, v144
    v_fma_f32 v84, v84, s61, -v184
    v_fma_f32 v85, v85, s61, -v184
    v_fma_f32 v86, v86, s61, -v184
    v_fma_f32 v87, v87, s61, -v184
    v_exp_f32 v84, v84
    v_exp_f32 v85, v85
    v_exp_f32 v86, v86
    v_exp_f32 v87, v87
    v_cvt_pk_bf16_f32 v146, v84, v85
    v_cvt_pk_bf16_f32 v147, v86, v87
    ds_write_b64 v199, v[146:147]
    v_add_f32 v144, v84, v85
    v_add_f32 v145, v86, v87
    v_add_f32 v144, v144, v145
    s_nop 1
    v_add_f32_dpp v144, v144, v144 row_ror:8 row_mask:0xf bank_mask:0xf
    s_nop 1
    v_add_f32_dpp v144, v144, v144 row_ror:4 row_mask:0xf bank_mask:0xf
    v_mov_b32 v4, v144
    s_nop 1
    v_permlane32_swap_b32 v144, v4
    v_add_f32 v144, v144, v4
    v_mov_b32 v4, v144
    s_nop 1
    v_permlane16_swap_b32 v144, v4
    v_add_f32 v144, v144, v4
    s_mov_b64 exec, 15
    ds_write_b32 v202, v144 offset:64
    s_mov_b64 exec, -1
    s_waitcnt lgkmcnt(0)
    s_barrier
    ds_read_b128 v[100:103], v200 offset:0
    ds_read_b128 v[104:107], v200 offset:256
    ds_read_b128 v[108:111], v200 offset:512
    ds_read_b128 v[112:115], v200 offset:768
    ds_read_b128 v[116:119], v200 offset:1024
    ds_read_b128 v[120:123], v200 offset:1280
    ds_read_b128 v[124:127], v200 offset:1536
    ds_read_b128 v[128:131], v200 offset:1792
    s_cmp_eq_u32 s5, 3
    s_cbranch_scc0 st_18
    ds_read_b128 v[148:151], v201 offset:64
    s_add_u32 s61, s44, s7
    s_add_u32 s61, s61, 1
    v_mov_b32 v186, s61
    s_waitcnt lgkmcnt(0)
    v_add_f32 v148, v148, v149
    v_add_f32 v150, v150, v151
    v_add_f32 v148, v148, v150
    v_mov_b32 v185, v148
st_18:
    ds_read_b64_tr_b16 a[64:65], v221 offset:0
    ds_read_b64_tr_b16 a[66:67], v221 offset:4096
    ds_read_b64_tr_b16 a[68:69], v222 offset:0
    ds_read_b64_tr_b16 a[70:71], v222 offset:4096
    ds_read_b64_tr_b16 a[72:73], v221 offset:8192
    ds_read_b64_tr_b16 a[74:75], v221 offset:12288
    ds_read_b64_tr_b16 a[76:77], v222 offset:8192
    ds_read_b64_tr_b16 a[78:79], v222 offset:12288
    ds_read_b64_tr_b16 a[80:81], v221 offset:16384
    ds_read_b64_tr_b16 a[82:83], v221 offset:20480
    ds_read_b64_tr_b16 a[84:85], v222 offset:16384
    ds_read_b64_tr_b16 a[86:87], v222 offset:20480
    ds_read_b64_tr_b16 a[88:89], v221 offset:24576
    ds_read_b64_tr_b16 a[90:91], v221 offset:28672
    ds_read_b64_tr_b16 a[92:93], v222 offset:24576
    ds_read_b64_tr_b16 a[94:95], v222 offset:28672
    s_waitcnt lgkmcnt(0)
    v_mfma_f32_16x16x32_bf16 v[68:71], a[64:67], v[100:103], 0
    v_mfma_f32_16x16x32_bf16 v[72:75], a[68:71], v[100:103], 0
    v_mfma_f32_16x16x32_bf16 v[68:71], a[72:75], v[104:107], v[68:71]
    v_mfma_f32_16x16x32_bf16 v[72:75], a[76:79], v[104:107], v[72:75]
    v_mfma_f32_16x16x32_bf16 v[68:71], a[80:83], v[108:111], v[68:71]
    v_mfma_f32_16x16x32_bf16 v[72:75], a[84:87], v[108:111], v[72:75]
    v_mfma_f32_16x16x32_bf16 v[68:71], a[88:91], v[112:115], v[68:71]
    v_mfma_f32_16x16x32_bf16 v[72:75], a[92:95], v[112:115], v[72:75]
    s_waitcnt vmcnt(4)
    s_barrier
    ds_read_b64_tr_b16 a[96:97], v221 offset:32768
    ds_read_b64_tr_b16 a[98:99], v221 offset:36864
    ds_read_b64_tr_b16 a[100:101], v222 offset:32768
    ds_read_b64_tr_b16 a[102:103], v222 offset:36864
    ds_read_b64_tr_b16 a[104:105], v221 offset:40960
    ds_read_b64_tr_b16 a[106:107], v221 offset:45056
    ds_read_b64_tr_b16 a[108:109], v222 offset:40960
    ds_read_b64_tr_b16 a[110:111], v222 offset:45056
    s_waitcnt lgkmcnt(0)
    v_mfma_f32_16x16x32_bf16 v[68:71], a[96:99], v[116:119], v[68:71]
    v_mfma_f32_16x16x32_bf16 v[72:75], a[100:103], v[116:119], v[72:75]
    v_mfma_f32_16x16x32_bf16 v[68:71], a[104:107], v[120:123], v[68:71]
    v_mfma_f32_16x16x32_bf16 v[72:75], a[108:111], v[120:123], v[72:75]
    s_waitcnt vmcnt(0)
    s_barrier
    ds_read_b64_tr_b16 a[112:113], v221 offset:49152
    ds_read_b64_tr_b16 a[114:115], v221 offset:53248
    ds_read_b64_tr_b16 a[116:117], v222 offset:49152
    ds_read_b64_tr_b16 a[118:119], v222 offset:53248
    ds_read_b64_tr_b16 a[120:121], v221 offset:57344
    ds_read_b64_tr_b16 a[122:123], v221 offset:61440
    ds_read_b64_tr_b16 a[124:125], v222 offset:57344
    ds_read_b64_tr_b16 a[126:127], v222 offset:61440
    s_waitcnt lgkmcnt(0)
    v_mfma_f32_16x16x32_bf16 v[68:71], a[112:115], v[124:127], v[68:71]
    v_mfma_f32_16x16x32_bf16 v[72:75], a[116:119], v[124:127], v[72:75]
    v_mfma_f32_16x16x32_bf16 v[68:71], a[120:123], v[128:131], v[68:71]
    v_mfma_f32_16x16x32_bf16 v[72:75], a[124:127], v[128:131], v[72:75]
    s_nop 6
    v_cvt_pk_bf16_f32 v144, v68, v69
    v_cvt_pk_bf16_f32 v145, v70, v71
    v_cvt_pk_bf16_f32 v146, v72, v73
    v_cvt_pk_bf16_f32 v147, v74, v75
    v_min_u32 v144, 0xfffffffe, v144
    v_min_u32 v145, 0xfffffffe, v145
    v_min_u32 v146, 0xfffffffe, v146
    v_min_u32 v147, 0xfffffffe, v147
    s_mov_b64 exec, s[50:51]
    s_cmp_eq_u32 s46, 0
    s_cbranch_scc1 stg_19
    buffer_store_dwordx4 v[144:147], v211, s[8:11], s66 offen
std_20:
    s_mov_b64 exec, -1
    s_cmp_eq_u32 s5, 3
    s_cbranch_scc0 ss_21
    s_mov_b64 exec, 15
    s_cmp_eq_u32 s46, 0
    s_cbranch_scc1 stg_22
    buffer_store_dwordx4 v[184:187], v212, s[8:11], s66 offen
std_23:
    s_mov_b64 exec, -1
ss_21:
    s_cmp_eq_u32 s5, 0
    s_cbranch_scc0 c1_24
    v_mov_b32 v152, -1
    v_mov_b32 v153, -1
    v_mov_b32 v154, -1
    v_mov_b32 v155, -1
    s_add_u32 s61, s66, 278528
    s_cmp_eq_u32 s46, 0
    s_cbranch_scc1 stg_25
    buffer_store_dwordx4 v[152:155], v192, s[8:11], s61 offen
std_26:
    s_mov_b32 exec_lo, 0x55555555
    s_mov_b32 exec_hi, 0x0
    buffer_store_dwordx2 v[178:179], v180, s[8:11], 0 offen sc1
    s_mov_b64 exec, -1
c1_24:
    s_lshl_b32 s65, s3, 7
    s_add_u32 s65, s65, 114688
    s_lshl_b32 s64, s6, 2
    s_add_u32 s64, s64, s65
    s_add_u32 s64, s64, 0
    s_add_u32 s59, s44, 8
    v_lshrrev_b32 v4, 2, v1
    v_lshlrev_b32 v4, 10, v4
    v_and_b32 v5, 3, v1
    v_lshl_add_u32 v4, v5, 4, v4
    s_lshl_b32 s61, s3, 19
    s_lshl_b32 s62, s5, 17
    s_add_u32 s61, s61, s62
    s_lshl_b32 s62, s6, 6
    s_add_u32 s61, s61, s62
    s_lshl_b32 s62, s5, 14
    s_add_u32 s62, s62, 16384
    s_mov_b32 m0, s62
    s_add_u32 s62, s62, 1024
    buffer_load_dwordx4 v4, s[24:27], s61 offen nt lds
    s_add_u32 s61, s61, 16384
    s_mov_b32 m0, s62
    s_add_u32 s62, s62, 1024
    buffer_load_dwordx4 v4, s[24:27], s61 offen nt lds
    s_add_u32 s61, s61, 16384
    s_mov_b32 m0, s62
    s_add_u32 s62, s62, 1024
    buffer_load_dwordx4 v4, s[24:27], s61 offen nt lds
    s_add_u32 s61, s61, 16384
    s_mov_b32 m0, s62
    s_add_u32 s62, s62, 1024
    buffer_load_dwordx4 v4, s[24:27], s61 offen nt lds
    s_add_u32 s61, s61, 16384
    s_mov_b32 m0, s62
    s_add_u32 s62, s62, 1024
    buffer_load_dwordx4 v4, s[24:27], s61 offen nt lds
    s_add_u32 s61, s61, 16384
    s_mov_b32 m0, s62
    s_add_u32 s62, s62, 1024
    buffer_load_dwordx4 v4, s[24:27], s61 offen nt lds
    s_add_u32 s61, s61, 16384
    s_mov_b32 m0, s62
    s_add_u32 s62, s62, 1024
    buffer_load_dwordx4 v4, s[24:27], s61 offen nt lds
    s_add_u32 s61, s61, 16384
    s_mov_b32 m0, s62
    s_add_u32 s62, s62, 1024
    buffer_load_dwordx4 v4, s[24:27], s61 offen nt lds
    s_add_u32 s61, s61, 16384
    v_mov_b32 v173, 0
    s_cmp_eq_u32 s3, 0
    s_cbranch_scc0 r0_27
    v_and_b32 v4, 1, v3
    v_lshlrev_b32 v4, 10, v4
    v_lshrrev_b32 v5, 1, v3
    v_lshl_add_u32 v4, v5, 5, v4
    v_lshl_add_u32 v4, v2, 1, v4
    s_lshl_b32 s61, s6, 6
    buffer_load_ushort v173, v4, s[36:39], s61 offen
r0_27:
    buffer_load_dwordx3 v[160:162], v195, s[8:11], s67 offen sc1
    buffer_load_dwordx3 v[164:166], v196, s[8:11], s67 offen sc1
    s_lshl_b32 s61, s5, 14
    v_lshrrev_b32 v5, 2, v2
    v_lshl_add_u32 v5, v3, 2, v5
    v_lshlrev_b32 v5, 6, v5
    v_and_b32 v6, 3, v2
    v_lshl_add_u32 v5, v6, 3, v5
    v_add_u32 v5, s61, v5
    v_add_u32 v4, 16384, v5
    s_waitcnt vmcnt(2)
    ds_read_b64_tr_b16 a[144:145], v4 offset:0
    ds_read_b64_tr_b16 a[146:147], v4 offset:1024
    ds_read_b64_tr_b16 a[148:149], v4 offset:32
    ds_read_b64_tr_b16 a[150:151], v4 offset:1056
    ds_read_b64_tr_b16 a[152:153], v4 offset:2048
    ds_read_b64_tr_b16 a[154:155], v4 offset:3072
    ds_read_b64_tr_b16 a[156:157], v4 offset:2080
    ds_read_b64_tr_b16 a[158:159], v4 offset:3104
    ds_read_b64_tr_b16 a[160:161], v4 offset:4096
    ds_read_b64_tr_b16 a[162:163], v4 offset:5120
    ds_read_b64_tr_b16 a[164:165], v4 offset:4128
    ds_read_b64_tr_b16 a[166:167], v4 offset:5152
    ds_read_b64_tr_b16 a[168:169], v4 offset:6144
    ds_read_b64_tr_b16 a[170:171], v4 offset:7168
    ds_read_b64_tr_b16 a[172:173], v4 offset:6176
    ds_read_b64_tr_b16 a[174:175], v4 offset:7200
    v_lshlrev_b32 v174, 16, v173
    s_waitcnt lgkmcnt(0)
    s_add_u32 s60, s44, 1
    s_waitcnt vmcnt(0)
    v_xor_b32 v4, s60, v162
    v_xor_b32 v5, s60, v166
    v_or_b32 v4, v4, v5
    v_cmp_ne_u32 vcc, 0, v4
    s_cbranch_vccz L_heavy
L_loopA:
    s_add_u32 s60, s44, s7
    s_add_u32 s60, s60, 1
os_28:
    buffer_load_dwordx3 v[160:162], v195, s[8:11], s67 offen sc1
    buffer_load_dwordx3 v[164:166], v196, s[8:11], s67 offen sc1
    s_waitcnt vmcnt(0)
    v_xor_b32 v4, s60, v162
    v_xor_b32 v5, s60, v166
    v_or_b32 v4, v4, v5
    v_cmp_ne_u32 vcc, 0, v4
    s_cbranch_vccz osok_29
    s_sub_u32 s47, s47, 1
    s_cbranch_scc0 os_28
    s_branch L_abort
osok_29:
L_heavy:
op_30:
    buffer_load_dwordx4 v[28:31], v193, s[8:11], s67 offen offset:0 sc1
    buffer_load_dwordx4 v[32:35], v193, s[8:11], s67 offen offset:1024 sc1
    buffer_load_dwordx4 v[36:39], v193, s[8:11], s67 offen offset:2048 sc1
    buffer_load_dwordx4 v[40:43], v193, s[8:11], s67 offen offset:3072 sc1
    buffer_load_dwordx4 v[44:47], v194, s[8:11], s67 offen offset:0 sc1
    buffer_load_dwordx4 v[48:51], v194, s[8:11], s67 offen offset:1024 sc1
    buffer_load_dwordx4 v[52:55], v194, s[8:11], s67 offen offset:2048 sc1
    buffer_load_dwordx4 v[56:59], v194, s[8:11], s67 offen offset:3072 sc1
    v_mov_b32 v144, v160
    v_mov_b32 v145, v164
    s_nop 0
    v_max_f32_dpp v144, v144, v144 row_ror:8 row_mask:0xf bank_mask:0xf
    v_max_f32_dpp v145, v145, v145 row_ror:8 row_mask:0xf bank_mask:0xf
    s_nop 0
    v_max_f32_dpp v144, v144, v144 row_ror:4 row_mask:0xf bank_mask:0xf
    v_max_f32_dpp v145, v145, v145 row_ror:4 row_mask:0xf bank_mask:0xf
    s_nop 0
    v_max_f32_dpp v144, v144, v144 row_ror:2 row_mask:0xf bank_mask:0xf
    v_max_f32_dpp v145, v145, v145 row_ror:2 row_mask:0xf bank_mask:0xf
    s_nop 0
    v_max_f32_dpp v144, v144, v144 row_ror:1 row_mask:0xf bank_mask:0xf
    v_max_f32_dpp v145, v145, v145 row_ror:1 row_mask:0xf bank_mask:0xf
    v_sub_f32 v144, v160, v144
    v_sub_f32 v145, v164, v145
    v_exp_f32 v144, v144
    v_exp_f32 v145, v145
    v_mul_f32 v146, v144, v161
    v_mul_f32 v147, v145, v165
    s_nop 0
    v_add_f32_dpp v146, v146, v146 row_ror:8 row_mask:0xf bank_mask:0xf
    v_add_f32_dpp v147, v147, v147 row_ror:8 row_mask:0xf bank_mask:0xf
    s_nop 0
    v_add_f32_dpp v146, v146, v146 row_ror:4 row_mask:0xf bank_mask:0xf
    v_add_f32_dpp v147, v147, v147 row_ror:4 row_mask:0xf bank_mask:0xf
    s_nop 0
    v_add_f32_dpp v146, v146, v146 row_ror:2 row_mask:0xf bank_mask:0xf
    v_add_f32_dpp v147, v147, v147 row_ror:2 row_mask:0xf bank_mask:0xf
    s_nop 0
    v_add_f32_dpp v146, v146, v146 row_ror:1 row_mask:0xf bank_mask:0xf
    v_add_f32_dpp v147, v147, v147 row_ror:1 row_mask:0xf bank_mask:0xf
    v_rcp_f32 v146, v146
    v_rcp_f32 v147, v147
    v_mul_f32 v168, v144, v146
    v_mul_f32 v169, v145, v147
    v_mov_b32 v4, 0
    s_waitcnt vmcnt(7)
    v_mfma_f32_16x16x32_bf16 v[68:71], v[28:31], a[144:147], 0
    v_mfma_f32_16x16x32_bf16 v[72:75], v[28:31], a[148:151], 0
    v_max3_u32 v4, v4, v28, v29
    v_max3_u32 v4, v4, v30, v31
    s_waitcnt vmcnt(6)
    v_mfma_f32_16x16x32_bf16 v[68:71], v[32:35], a[152:155], v[68:71]
    v_mfma_f32_16x16x32_bf16 v[72:75], v[32:35], a[156:159], v[72:75]
    v_max3_u32 v4, v4, v32, v33
    v_max3_u32 v4, v4, v34, v35
    s_waitcnt vmcnt(5)
    v_mfma_f32_16x16x32_bf16 v[68:71], v[36:39], a[160:163], v[68:71]
    v_mfma_f32_16x16x32_bf16 v[72:75], v[36:39], a[164:167], v[72:75]
    v_max3_u32 v4, v4, v36, v37
    v_max3_u32 v4, v4, v38, v39
    s_waitcnt vmcnt(4)
    v_mfma_f32_16x16x32_bf16 v[68:71], v[40:43], a[168:171], v[68:71]
    v_mfma_f32_16x16x32_bf16 v[72:75], v[40:43], a[172:175], v[72:75]
    v_max3_u32 v4, v4, v40, v41
    v_max3_u32 v4, v4, v42, v43
    s_waitcnt vmcnt(3)
    v_mfma_f32_16x16x32_bf16 v[76:79], v[44:47], a[144:147], 0
    v_mfma_f32_16x16x32_bf16 v[80:83], v[44:47], a[148:151], 0
    v_max3_u32 v4, v4, v44, v45
    v_max3_u32 v4, v4, v46, v47
    s_waitcnt vmcnt(2)
    v_mfma_f32_16x16x32_bf16 v[76:79], v[48:51], a[152:155], v[76:79]
    v_mfma_f32_16x16x32_bf16 v[80:83], v[48:51], a[156:159], v[80:83]
    v_max3_u32 v4, v4, v48, v49
    v_mul_f32_dpp v148, v168, v68 row_newbcast:0 row_mask:0xf bank_mask:0xf
    v_mul_f32_dpp v149, v168, v72 row_newbcast:0 row_mask:0xf bank_mask:0xf
    v_max3_u32 v4, v4, v50, v51
    s_waitcnt vmcnt(1)
    v_mfma_f32_16x16x32_bf16 v[76:79], v[52:55], a[160:163], v[76:79]
    v_mfma_f32_16x16x32_bf16 v[80:83], v[52:55], a[164:167], v[80:83]
    v_max3_u32 v4, v4, v52, v53
    v_fmac_f32_dpp v148, v168, v69 row_newbcast:1 row_mask:0xf bank_mask:0xf
    v_fmac_f32_dpp v149, v168, v73 row_newbcast:1 row_mask:0xf bank_mask:0xf
    v_max3_u32 v4, v4, v54, v55
    s_waitcnt vmcnt(0)
    v_mfma_f32_16x16x32_bf16 v[76:79], v[56:59], a[168:171], v[76:79]
    v_mfma_f32_16x16x32_bf16 v[80:83], v[56:59], a[172:175], v[80:83]
    v_max3_u32 v4, v4, v56, v57
    v_fmac_f32_dpp v148, v168, v70 row_newbcast:2 row_mask:0xf bank_mask:0xf
    v_fmac_f32_dpp v149, v168, v74 row_newbcast:2 row_mask:0xf bank_mask:0xf
    s_nop 0
    v_fmac_f32_dpp v148, v168, v71 row_newbcast:3 row_mask:0xf bank_mask:0xf
    v_fmac_f32_dpp v149, v168, v75 row_newbcast:3 row_mask:0xf bank_mask:0xf
    v_max3_u32 v4, v4, v58, v59
    v_cmp_eq_u32 vcc, -1, v4
    s_cbranch_vccz ook_31
    s_sub_u32 s47, s47, 1
    s_cbranch_scc0 op_30
    s_branch L_abort
ook_31:
    v_mul_f32_dpp v150, v169, v76 row_newbcast:0 row_mask:0xf bank_mask:0xf
    v_mul_f32_dpp v151, v169, v80 row_newbcast:0 row_mask:0xf bank_mask:0xf
    s_nop 0
    v_fmac_f32_dpp v150, v169, v77 row_newbcast:1 row_mask:0xf bank_mask:0xf
    v_fmac_f32_dpp v151, v169, v81 row_newbcast:1 row_mask:0xf bank_mask:0xf
    s_nop 0
    v_fmac_f32_dpp v150, v169, v78 row_newbcast:2 row_mask:0xf bank_mask:0xf
    v_fmac_f32_dpp v151, v169, v82 row_newbcast:2 row_mask:0xf bank_mask:0xf
    s_nop 0
    v_fmac_f32_dpp v150, v169, v79 row_newbcast:3 row_mask:0xf bank_mask:0xf
    v_fmac_f32_dpp v151, v169, v83 row_newbcast:3 row_mask:0xf bank_mask:0xf
    v_permlane32_swap_b32 v148, v149
    s_nop 0
    v_permlane32_swap_b32 v150, v151
    v_add_f32 v148, v148, v149
    v_add_f32 v150, v150, v151
    s_nop 1
    v_permlane16_swap_b32 v148, v150
    v_add_f32 v144, v148, v150
    ds_write_b32 v203, v144 offset:5632
    s_waitcnt lgkmcnt(0)
    s_barrier
    s_cmp_eq_u32 s5, 0
    s_cbranch_scc0 of_32
    ds_read_b128 v[144:147], v208 offset:5632
    v_mov_b32 v4, 0
    v_mov_b32 v5, s59
    s_waitcnt lgkmcnt(0)
    v_add_f32 v144, v144, v145
    v_add_f32 v146, v146, v147
    v_add_f32 v144, v144, v174
    v_add_f32 v174, v144, v146
    s_nop 1
    v_mov_b32_dpp v145, v174 quad_perm:[1,0,3,2] row_mask:0xf bank_mask:0xf
    v_cvt_pk_bf16_f32 v144, v174, v145
    v_min_u32 v144, 0xfffffffe, v144
    s_mov_b64 exec, 1
    s_cmp_eq_u32 s46, 0
    s_cbranch_scc1 stg_33
    buffer_store_dword v5, v4, s[8:11], s64 offen
std_34:
    s_xor_b32 s61, s68, 0x2000
    s_add_u32 s61, s61, 16384
    s_mov_b64 exec, s[56:57]
    buffer_store_dword v144, v210, s[8:11], s68 offen sc1
    buffer_store_dword v144, v210, s[8:11], s61 offen sc1
    s_mov_b64 exec, -1
of_32:
    s_add_u32 s68, s68, 32768
    s_add_u32 s64, s64, 1024
    s_add_u32 s59, s59, 1
    s_cmp_eq_u32 s7, 0
    s_cbranch_scc0 dn_35
    v_lshrrev_b32 v4, 2, v1
    v_lshlrev_b32 v4, 10, v4
    v_and_b32 v5, 3, v1
    v_lshl_add_u32 v4, v5, 4, v4
    s_mul_i32 s61, s3, 229376
    s_lshl_b32 s62, s6, 6
    s_add_u32 s61, s61, s62
    s_lshl_b32 s62, s5, 15
    s_add_u32 s61, s61, s62
    s_lshl_b32 s62, s5, 14
    s_add_u32 s62, s62, 24576
    s_mov_b32 m0, s62
    s_add_u32 s63, s61, 16384
    buffer_load_dwordx4 v4, s[32:35], s61 offen nt lds
    s_add_u32 s62, s62, 1024
    s_mov_b32 m0, s62
    s_nop 0
    buffer_load_dwordx4 v4, s[32:35], s63 offen nt lds
    s_cmp_eq_u32 s5, 3
    s_cbranch_scc1 L_nod2
    s_add_u32 s61, s61, 131072
    s_add_u32 s62, s62, 1024
    s_mov_b32 m0, s62
    s_add_u32 s63, s61, 16384
    buffer_load_dwordx4 v4, s[32:35], s61 offen nt lds
    s_add_u32 s62, s62, 1024
    s_mov_b32 m0, s62
    s_nop 0
    buffer_load_dwordx4 v4, s[32:35], s63 offen nt lds
L_nod2:
    s_lshl_b32 s60, s5, 13
    s_add_u32 s60, s60, 65540
    v_lshlrev_b32 v175, 7, v1
    buffer_load_dword v176, v175, s[8:11], s60 offen sc1
    s_waitcnt vmcnt(1)
    s_lshl_b32 s61, s5, 14
    v_lshrrev_b32 v5, 2, v2
    v_lshl_add_u32 v5, v3, 3, v5
    v_lshlrev_b32 v5, 6, v5
    v_and_b32 v6, 3, v2
    v_lshl_add_u32 v5, v6, 3, v5
    v_add_u32 v5, s61, v5
    v_add_u32 v4, 24576, v5
    ds_read_b64_tr_b16 a[176:177], v4 offset:0
    ds_read_b64_tr_b16 a[178:179], v4 offset:256
    ds_read_b64_tr_b16 a[180:181], v4 offset:32
    ds_read_b64_tr_b16 a[182:183], v4 offset:288
    s_cmp_eq_u32 s5, 3
    s_cbranch_scc1 L_dn3
    ds_read_b64_tr_b16 a[184:185], v4 offset:2048
    ds_read_b64_tr_b16 a[186:187], v4 offset:2304
    ds_read_b64_tr_b16 a[188:189], v4 offset:2080
    ds_read_b64_tr_b16 a[190:191], v4 offset:2336
    s_branch L_dn4
L_dn3:
    v_accvgpr_write_b32 a184, 0
    v_accvgpr_write_b32 a185, 0
    v_accvgpr_write_b32 a186, 0
    v_accvgpr_write_b32 a187, 0
    v_accvgpr_write_b32 a188, 0
    v_accvgpr_write_b32 a189, 0
    v_accvgpr_write_b32 a190, 0
    v_accvgpr_write_b32 a191, 0
L_dn4:
    s_lshl_b32 s60, s5, 13
    s_add_u32 s60, s60, 65540
tc_36:
    s_waitcnt vmcnt(0)
    v_xor_b32 v176, s44, v176
    v_cmp_lt_u32 vcc, 15, v176
    s_cbranch_vccz tcok_37
    s_sleep 2
    buffer_load_dword v176, v175, s[8:11], s60 offen sc1
    s_sub_u32 s47, s47, 1
    s_cbranch_scc0 tc_36
    s_branch L_abort
tcok_37:
    s_waitcnt lgkmcnt(0)
    s_barrier
dn_35:
    s_cmp_eq_u32 s5, 3
    s_cbranch_scc1 dp1_44
    s_mov_b64 exec, s[52:53]
dp_41:
    buffer_load_dwordx4 v[136:139], v198, s[8:11], s96 offen sc1
    buffer_load_dwordx4 v[140:143], v198, s[8:11], s96 offen offset:512 sc1
    s_waitcnt vmcnt(0)
    v_max3_u32 v5, v136, v137, v138
    v_max3_u32 v5, v5, v139, v140
    v_max3_u32 v5, v5, v141, v142
    v_max_u32 v5, v5, v143
    v_cmp_eq_u32 vcc, -1, v5
    s_cbranch_vccz dok_42
    s_sub_u32 s47, s47, 1
    s_cbranch_scc0 dp_41
    s_branch L_abort
dp1_44:
    s_mov_b64 exec, s[52:53]
dp1_44b:
    buffer_load_dwordx4 v[136:139], v198, s[8:11], s96 offen sc1
    s_waitcnt vmcnt(0)
    v_max3_u32 v5, v136, v137, v138
    v_max_u32 v5, v5, v139
    v_cmp_eq_u32 vcc, -1, v5
    s_cbranch_vccz dok_42
    s_sub_u32 s47, s47, 1
    s_cbranch_scc0 dp1_44b
    s_branch L_abort
dok_42:
    s_mov_b64 exec, -1
    s_nop 0
    v_mfma_f32_16x16x32_bf16 v[68:71], v[136:139], a[176:179], 0
    v_mfma_f32_16x16x32_bf16 v[72:75], v[136:139], a[180:183], 0
    v_mfma_f32_16x16x32_bf16 v[68:71], v[140:143], a[184:187], v[68:71]
    v_mfma_f32_16x16x32_bf16 v[72:75], v[140:143], a[188:191], v[72:75]
    s_nop 6
    v_permlane16_swap_b32 v68, v69
    v_permlane16_swap_b32 v72, v73
    s_nop 1
    v_permlane32_swap_b32 v68, v72
    ds_write_b32 v203, v68 offset:6656
    s_waitcnt lgkmcnt(0)
    s_barrier
    s_cmp_eq_u32 s5, 0
    s_cbranch_scc0 df_45
    ds_read_b128 v[144:147], v208 offset:6656
    v_mov_b32 v4, 0
    v_mov_b32 v5, s59
    s_waitcnt lgkmcnt(0)
    v_add_f32 v144, v144, v145
    v_add_f32 v146, v146, v147
    v_add_f32 v144, v144, v174
    v_add_f32 v174, v144, v146
    s_nop 1
    v_mov_b32_dpp v145, v174 quad_perm:[1,0,3,2] row_mask:0xf bank_mask:0xf
    v_cvt_pk_bf16_f32 v144, v174, v145
    v_min_u32 v144, 0xfffffffe, v144
    s_mov_b64 exec, 1
    s_cmp_eq_u32 s46, 0
    s_cbranch_scc1 stg_46
    buffer_store_dword v5, v4, s[8:11], s64 offen
std_47:
    s_xor_b32 s61, s68, 0x2000
    s_add_u32 s61, s61, 16384
    s_mov_b64 exec, s[56:57]
    buffer_store_dword v144, v210, s[8:11], s68 offen sc1
    buffer_store_dword v144, v210, s[8:11], s61 offen sc1
    s_mov_b64 exec, -1
df_45:
    s_add_u32 s68, s68, 32768
    s_add_u32 s64, s64, 1024
    s_add_u32 s59, s59, 1
    s_cmp_eq_u32 s7, 1
    s_cbranch_scc1 L_finalA
    s_branch L_q2s2
L_roleB:
    ds_read_b128 v[148:151], v201
    s_mov_b32 s61, 0x3e0293ee
    s_waitcnt lgkmcnt(0)
    v_max3_f32 v144, v148, v149, v150
    v_max_f32 v144, v144, v151
    v_mul_f32 v184, s61, v144
    v_fma_f32 v84, v84, s61, -v184
    v_fma_f32 v85, v85, s61, -v184
    v_fma_f32 v86, v86, s61, -v184
    v_fma_f32 v87, v87, s61, -v184
    v_exp_f32 v84, v84
    v_exp_f32 v85, v85
    v_exp_f32 v86, v86
    v_exp_f32 v87, v87
    v_cvt_pk_bf16_f32 v146, v84, v85
    v_cvt_pk_bf16_f32 v147, v86, v87
    ds_write_b64 v199, v[146:147]
    v_add_f32 v144, v84, v85
    v_add_f32 v145, v86, v87
    v_add_f32 v144, v144, v145
    s_nop 1
    v_add_f32_dpp v144, v144, v144 row_ror:8 row_mask:0xf bank_mask:0xf
    s_nop 1
    v_add_f32_dpp v144, v144, v144 row_ror:4 row_mask:0xf bank_mask:0xf
    v_mov_b32 v4, v144
    s_nop 1
    v_permlane32_swap_b32 v144, v4
    v_add_f32 v144, v144, v4
    v_mov_b32 v4, v144
    s_nop 1
    v_permlane16_swap_b32 v144, v4
    v_add_f32 v144, v144, v4
    s_mov_b64 exec, 15
    ds_write_b32 v202, v144 offset:64
    s_mov_b64 exec, -1
    s_waitcnt lgkmcnt(0)
    s_barrier
    ds_read_b128 v[100:103], v200 offset:0
    ds_read_b128 v[104:107], v200 offset:256
    ds_read_b128 v[108:111], v200 offset:512
    ds_read_b128 v[112:115], v200 offset:768
    ds_read_b128 v[116:119], v200 offset:1024
    ds_read_b128 v[120:123], v200 offset:1280
    ds_read_b128 v[124:127], v200 offset:1536
    ds_read_b128 v[128:131], v200 offset:1792
    s_cmp_eq_u32 s5, 3
    s_cbranch_scc0 st_48
    ds_read_b128 v[148:151], v201 offset:64
    s_add_u32 s61, s44, s7
    s_add_u32 s61, s61, 1
    v_mov_b32 v186, s61
    s_waitcnt lgkmcnt(0)
    v_add_f32 v148, v148, v149
    v_add_f32 v150, v150, v151
    v_add_f32 v148, v148, v150
    v_mov_b32 v185, v148
st_48:
    ds_read_b64_tr_b16 a[64:65], v221 offset:0
    ds_read_b64_tr_b16 a[66:67], v221 offset:4096
    ds_read_b64_tr_b16 a[68:69], v222 offset:0
    ds_read_b64_tr_b16 a[70:71], v222 offset:4096
    ds_read_b64_tr_b16 a[72:73], v221 offset:8192
    ds_read_b64_tr_b16 a[74:75], v221 offset:12288
    ds_read_b64_tr_b16 a[76:77], v222 offset:8192
    ds_read_b64_tr_b16 a[78:79], v222 offset:12288
    ds_read_b64_tr_b16 a[80:81], v221 offset:16384
    ds_read_b64_tr_b16 a[82:83], v221 offset:20480
    ds_read_b64_tr_b16 a[84:85], v222 offset:16384
    ds_read_b64_tr_b16 a[86:87], v222 offset:20480
    ds_read_b64_tr_b16 a[88:89], v221 offset:24576
    ds_read_b64_tr_b16 a[90:91], v221 offset:28672
    ds_read_b64_tr_b16 a[92:93], v222 offset:24576
    ds_read_b64_tr_b16 a[94:95], v222 offset:28672
    s_waitcnt lgkmcnt(0)
    v_mfma_f32_16x16x32_bf16 v[68:71], a[64:67], v[100:103], 0
    v_mfma_f32_16x16x32_bf16 v[72:75], a[68:71], v[100:103], 0
    v_mfma_f32_16x16x32_bf16 v[68:71], a[72:75], v[104:107], v[68:71]
    v_mfma_f32_16x16x32_bf16 v[72:75], a[76:79], v[104:107], v[72:75]
    v_mfma_f32_16x16x32_bf16 v[68:71], a[80:83], v[108:111], v[68:71]
    v_mfma_f32_16x16x32_bf16 v[72:75], a[84:87], v[108:111], v[72:75]
    v_mfma_f32_16x16x32_bf16 v[68:71], a[88:91], v[112:115], v[68:71]
    v_mfma_f32_16x16x32_bf16 v[72:75], a[92:95], v[112:115], v[72:75]
    s_waitcnt vmcnt(4)
    s_barrier
    ds_read_b64_tr_b16 a[96:97], v221 offset:32768
    ds_read_b64_tr_b16 a[98:99], v221 offset:36864
    ds_read_b64_tr_b16 a[100:101], v222 offset:32768
    ds_read_b64_tr_b16 a[102:103], v222 offset:36864
    ds_read_b64_tr_b16 a[104:105], v221 offset:40960
    ds_read_b64_tr_b16 a[106:107], v221 offset:45056
    ds_read_b64_tr_b16 a[108:109], v222 offset:40960
    ds_read_b64_tr_b16 a[110:111], v222 offset:45056
    s_waitcnt lgkmcnt(0)
    v_mfma_f32_16x16x32_bf16 v[68:71], a[96:99], v[116:119], v[68:71]
    v_mfma_f32_16x16x32_bf16 v[72:75], a[100:103], v[116:119], v[72:75]
    v_mfma_f32_16x16x32_bf16 v[68:71], a[104:107], v[120:123], v[68:71]
    v_mfma_f32_16x16x32_bf16 v[72:75], a[108:111], v[120:123], v[72:75]
    s_waitcnt vmcnt(0)
    s_barrier
    ds_read_b64_tr_b16 a[112:113], v221 offset:49152
    ds_read_b64_tr_b16 a[114:115], v221 offset:53248
    ds_read_b64_tr_b16 a[116:117], v222 offset:49152
    ds_read_b64_tr_b16 a[118:119], v222 offset:53248
    ds_read_b64_tr_b16 a[120:121], v221 offset:57344
    ds_read_b64_tr_b16 a[122:123], v221 offset:61440
    ds_read_b64_tr_b16 a[124:125], v222 offset:57344
    ds_read_b64_tr_b16 a[126:127], v222 offset:61440
    s_waitcnt lgkmcnt(0)
    v_mfma_f32_16x16x32_bf16 v[68:71], a[112:115], v[124:127], v[68:71]
    v_mfma_f32_16x16x32_bf16 v[72:75], a[116:119], v[124:127], v[72:75]
    v_mfma_f32_16x16x32_bf16 v[68:71], a[120:123], v[128:131], v[68:71]
    v_mfma_f32_16x16x32_bf16 v[72:75], a[124:127], v[128:131], v[72:75]
    s_nop 6
    v_cvt_pk_bf16_f32 v144, v68, v69
    v_cvt_pk_bf16_f32 v145, v70, v71
    v_cvt_pk_bf16_f32 v146, v72, v73
    v_cvt_pk_bf16_f32 v147, v74, v75
    v_min_u32 v144, 0xfffffffe, v144
    v_min_u32 v145, 0xfffffffe, v145
    v_min_u32 v146, 0xfffffffe, v146
    v_min_u32 v147, 0xfffffffe, v147
    s_mov_b64 exec, s[50:51]
    s_cmp_eq_u32 s46, 0
    s_cbranch_scc1 stg_49
    buffer_store_dwordx4 v[144:147], v211, s[8:11], s66 offen
std_50:
    s_mov_b64 exec, -1
    s_cmp_eq_u32 s5, 3
    s_cbranch_scc0 ss_51
    s_mov_b64 exec, 15
    s_cmp_eq_u32 s46, 0
    s_cbranch_scc1 stg_52
    buffer_store_dwordx4 v[184:187], v212, s[8:11], s66 offen
std_53:
    s_mov_b64 exec, -1
ss_51:
    s_cmp_eq_u32 s5, 0
    s_cbranch_scc0 c1_54
    v_mov_b32 v152, -1
    v_mov_b32 v153, -1
    v_mov_b32 v154, -1
    v_mov_b32 v155, -1
    s_add_u32 s61, s66, 278528
    s_cmp_eq_u32 s46, 0
    s_cbranch_scc1 stg_55
    buffer_store_dwordx4 v[152:155], v192, s[8:11], s61 offen
std_56:
    s_mov_b32 exec_lo, 0x55555555
    s_mov_b32 exec_hi, 0x0
    buffer_store_dwordx2 v[178:179], v180, s[8:11], 0 offen sc1
    s_mov_b64 exec, -1
c1_54:
    s_lshl_b32 s65, s3, 7
    s_add_u32 s65, s65, 114688
    s_lshl_b32 s64, s6, 2
    s_add_u32 s64, s64, s65
    s_add_u32 s64, s64, 1024
    s_add_u32 s59, s44, 9
    v_mul_u32_u24 v4, 52, v1
    v_lshrrev_b32 v4, 8, v4
    v_mul_u32_u24 v5, 5, v4
    v_sub_u32 v5, v1, v5
    v_mul_u32_u24 v4, 3584, v4
    v_lshl_add_u32 v4, v5, 7, v4
    s_lshl_b32 s61, s6, 5
    s_lshl_b32 s62, s5, 3
    s_add_u32 s61, s61, s62
    s_mul_i32 s61, s61, 3584
    s_mul_i32 s62, s3, 448
    s_and_b32 s62, s62, 0xffffff80
    s_add_u32 s61, s61, s62
    s_mov_b32 exec_lo, 0xffffffff
    s_mov_b32 exec_hi, 0xff
    buffer_load_dword v132, v4, s[24:27], s61 offen offset:0
    buffer_load_dword v132, v4, s[28:31], s61 offen offset:0
    s_mov_b64 exec, -1
    s_cmp_ge_u32 s6, 14
    s_cbranch_scc1 L_nogu
    v_lshrrev_b32 v4, 1, v1
    v_mul_u32_u24 v4, 3584, v4
    v_and_b32 v5, 1, v1
    v_lshl_add_u32 v4, v5, 4, v4
    s_mul_i32 s61, s5, 458752
    s_mul_i32 s62, s3, 448
    s_add_u32 s61, s61, s62
    s_lshl_b32 s62, s6, 5
    s_add_u32 s61, s61, s62
    s_lshl_b32 s62, s5, 14
    s_add_u32 s62, s62, 16384
    s_mov_b32 m0, s62
    s_add_u32 s63, s62, 4096
    buffer_load_dwordx4 v4, s[24:27], s61 offen nt lds
    s_mov_b32 m0, s63
    s_add_u32 s62, s62, 1024
    buffer_load_dwordx4 v4, s[28:31], s61 offen nt lds
    s_add_u32 s61, s61, 114688
    s_mov_b32 m0, s62
    s_add_u32 s63, s62, 4096
    buffer_load_dwordx4 v4, s[24:27], s61 offen nt lds
    s_mov_b32 m0, s63
    s_add_u32 s62, s62, 1024
    buffer_load_dwordx4 v4, s[28:31], s61 offen nt lds
    s_add_u32 s61, s61, 114688
    s_mov_b32 m0, s62
    s_add_u32 s63, s62, 4096
    buffer_load_dwordx4 v4, s[24:27], s61 offen nt lds
    s_mov_b32 m0, s63
    s_add_u32 s62, s62, 1024
    buffer_load_dwordx4 v4, s[28:31], s61 offen nt lds
    s_add_u32 s61, s61, 114688
    s_mov_b32 m0, s62
    s_add_u32 s63, s62, 4096
    buffer_load_dwordx4 v4, s[24:27], s61 offen nt lds
    s_mov_b32 m0, s63
    s_add_u32 s62, s62, 1024
    buffer_load_dwordx4 v4, s[28:31], s61 offen nt lds
    s_add_u32 s61, s61, 114688
L_nogu:
    s_lshl_b32 s60, s5, 13
    s_add_u32 s60, s60, 65540
    v_lshlrev_b32 v175, 7, v1
    buffer_load_dword v176, v175, s[8:11], s60 offen sc1
    s_waitcnt vmcnt(1)
    s_cmp_ge_u32 s6, 14
    s_cbranch_scc1 L_nogu2
    s_lshl_b32 s61, s5, 14
    v_lshrrev_b32 v5, 2, v2
    v_lshl_add_u32 v5, v3, 3, v5
    v_lshlrev_b32 v5, 5, v5
    v_and_b32 v6, 3, v2
    v_lshl_add_u32 v5, v6, 3, v5
    v_add_u32 v5, s61, v5
    v_add_u32 v4, 16384, v5
    ds_read_b64_tr_b16 a[144:145], v4 offset:0
    ds_read_b64_tr_b16 a[146:147], v4 offset:128
    ds_read_b64_tr_b16 a[148:149], v4 offset:4096
    ds_read_b64_tr_b16 a[150:151], v4 offset:4224
    ds_read_b64_tr_b16 a[152:153], v4 offset:1024
    ds_read_b64_tr_b16 a[154:155], v4 offset:1152
    ds_read_b64_tr_b16 a[156:157], v4 offset:5120
    ds_read_b64_tr_b16 a[158:159], v4 offset:5248
    ds_read_b64_tr_b16 a[160:161], v4 offset:2048
    ds_read_b64_tr_b16 a[162:163], v4 offset:2176
    ds_read_b64_tr_b16 a[164:165], v4 offset:6144
    ds_read_b64_tr_b16 a[166:167], v4 offset:6272
    ds_read_b64_tr_b16 a[168:169], v4 offset:3072
    ds_read_b64_tr_b16 a[170:171], v4 offset:3200
    ds_read_b64_tr_b16 a[172:173], v4 offset:7168
    ds_read_b64_tr_b16 a[174:175], v4 offset:7296
    s_waitcnt lgkmcnt(0)
    v_mfma_f32_16x16x32_bf16 v[68:71], v[8:11], a[144:147], 0
    v_mfma_f32_16x16x32_bf16 v[72:75], v[8:11], a[148:151], 0
    v_mfma_f32_16x16x32_bf16 v[68:71], v[8:11], a[152:155], v[68:71]
    v_mfma_f32_16x16x32_bf16 v[72:75], v[8:11], a[156:159], v[72:75]
    v_mfma_f32_16x16x32_bf16 v[68:71], v[8:11], a[160:163], v[68:71]
    v_mfma_f32_16x16x32_bf16 v[72:75], v[8:11], a[164:167], v[72:75]
    v_mfma_f32_16x16x32_bf16 v[68:71], v[8:11], a[168:171], v[68:71]
    v_mfma_f32_16x16x32_bf16 v[72:75], v[8:11], a[172:175], v[72:75]
    s_nop 7
    ds_write_b32 v203, v68 offset:7680
    ds_write_b32 v203, v72 offset:8704
L_nogu2:
    s_lshl_b32 s60, s5, 13
    s_add_u32 s60, s60, 65540
tc_57:
    s_waitcnt vmcnt(0)
    v_xor_b32 v176, s44, v176
    v_cmp_lt_u32 vcc, 15, v176
    s_cbranch_vccz tcok_58
    s_sleep 2
    buffer_load_dword v176, v175, s[8:11], s60 offen sc1
    s_sub_u32 s47, s47, 1
    s_cbranch_scc0 tc_57
    s_branch L_abort
tcok_58:
    s_waitcnt lgkmcnt(0)
    s_barrier
    s_xor_b32 s61, s4, 30
    s_or_b32 s61, s61, s3
    s_or_b32 s61, s61, s5
    s_cmp_eq_u32 s61, 0
    s_cbranch_scc0 ep_59
    v_mov_b32 v4, 0
    v_mov_b32 v5, s44
    s_mov_b64 exec, 1
    buffer_store_dword v5, v4, s[8:11], 0 offen sc1
    s_mov_b64 exec, -1
ep_59:
    ds_read_b128 v[144:147], v205 offset:7680
    ds_read_b128 v[148:151], v205 offset:8704
    s_waitcnt lgkmcnt(0)
    v_add_f32 v144, v144, v145
    v_add_f32 v146, v146, v147
    v_add_f32 v144, v144, v146
    v_add_f32 v148, v148, v149
    v_add_f32 v150, v150, v151
    v_add_f32 v148, v148, v150
    v_mov_b32 v171, v144
    v_mov_b32 v172, v148
L_loopB:
    s_cmp_ge_u32 s6, 14
    s_cbranch_scc1 nog_60
    s_lshl_b32 s60, s7, 11
    s_add_u32 s60, s60, s65
    s_add_u32 s60, s60, 0
    s_lshl_b32 s62, s7, 1
    s_add_u32 s62, s62, s44
    s_add_u32 s62, s62, 8
    v_lshlrev_b32 v4, 2, v1
    s_mov_b64 exec, 0xffff
db_61:
    buffer_load_dword v5, v4, s[8:11], s60 offen sc1
    s_waitcnt vmcnt(0)
    v_cmp_ne_u32 vcc, s62, v5
    s_cbranch_vccz dbok_62
    s_sub_u32 s47, s47, 1
    s_cbranch_scc0 db_61
    s_branch L_abort
dbok_62:
    s_mov_b64 exec, -1
    s_mov_b32 m0, s58
xp_63:
    s_nop 0
    buffer_load_dwordx4 v189, s[8:11], s69 offen offset:0 sc1 lds
    buffer_load_dwordx4 v189, s[8:11], s69 offen offset:1024 sc1 lds
    buffer_load_dwordx4 v189, s[8:11], s69 offen offset:2048 sc1 lds
    buffer_load_dwordx4 v189, s[8:11], s69 offen offset:3072 sc1 lds
    s_waitcnt vmcnt(3)
    ds_read_b128 v[28:31], v190 offset:0
    s_waitcnt vmcnt(2)
    ds_read_b128 v[32:35], v190 offset:1024
    s_waitcnt vmcnt(1)
    ds_read_b128 v[36:39], v190 offset:2048
    s_waitcnt vmcnt(0)
    ds_read_b128 v[40:43], v190 offset:3072
    s_waitcnt lgkmcnt(3)
    v_max3_u32 v4, v28, v29, v30
    s_waitcnt lgkmcnt(2)
    v_max3_u32 v4, v4, v31, v32
    v_max3_u32 v4, v4, v33, v34
    s_waitcnt lgkmcnt(1)
    v_max3_u32 v4, v4, v35, v36
    v_max3_u32 v4, v4, v37, v38
    s_waitcnt lgkmcnt(0)
    v_max3_u32 v4, v4, v39, v40
    v_max3_u32 v4, v4, v41, v42
    v_max_u32 v4, v4, v43
    v_cmp_eq_u32 vcc, -1, v4
    s_cbranch_vccz xok_64
    s_sub_u32 s47, s47, 1
    s_cbranch_scc0 xp_63
    s_branch L_abort
xok_64:
    v_mfma_f32_16x16x32_bf16 v[76:79], v[28:31], v[28:31], 0
    v_mfma_f32_16x16x32_bf16 v[76:79], v[32:35], v[32:35], v[76:79]
    v_mfma_f32_16x16x32_bf16 v[76:79], v[36:39], v[36:39], v[76:79]
    v_mfma_f32_16x16x32_bf16 v[76:79], v[40:43], v[40:43], v[76:79]
    v_mfma_f32_16x16x32_bf16 v[80:83], v[28:31], v[8:11], 0
    v_mfma_f32_16x16x32_bf16 v[80:83], v[32:35], v[8:11], v[80:83]
    v_mfma_f32_16x16x32_bf16 v[80:83], v[36:39], v[8:11], v[80:83]
    v_mfma_f32_16x16x32_bf16 v[80:83], v[40:43], v[8:11], v[80:83]
    v_mfma_f32_16x16x32_bf16 v[68:71], v[28:31], a[144:147], 0
    s_nop 2
    v_add_f32 v144, v76, v77
    v_add_f32 v7, v78, v79
    v_mfma_f32_16x16x32_bf16 v[72:75], v[28:31], a[148:151], 0
    v_add_f32 v144, v144, v7
    v_cndmask_b32 v144, 0, v144, s[48:49]
    v_mfma_f32_16x16x32_bf16 v[68:71], v[32:35], a[152:155], v[68:71]
    s_nop 0
    v_add_f32_dpp v144, v144, v144 row_ror:8 row_mask:0xf bank_mask:0xf
    s_nop 1
    v_add_f32_dpp v144, v144, v144 row_ror:4 row_mask:0xf bank_mask:0xf
    v_mfma_f32_16x16x32_bf16 v[72:75], v[32:35], a[156:159], v[72:75]
    s_nop 0
    v_add_f32_dpp v144, v144, v144 row_ror:2 row_mask:0xf bank_mask:0xf
    s_nop 1
    v_add_f32_dpp v144, v144, v144 row_ror:1 row_mask:0xf bank_mask:0xf
    v_mfma_f32_16x16x32_bf16 v[68:71], v[36:39], a[160:163], v[68:71]
    v_add_f32 v145, v80, v81
    v_add_f32 v7, v82, v83
    v_mfma_f32_16x16x32_bf16 v[72:75], v[36:39], a[164:167], v[72:75]
    v_add_f32 v145, v145, v7
    v_cndmask_b32 v144, v145, v144, s[54:55]
    v_mfma_f32_16x16x32_bf16 v[68:71], v[40:43], a[168:171], v[68:71]
    v_mov_b32 v145, v144
    s_nop 1
    v_permlane16_swap_b32 v144, v145
    v_mfma_f32_16x16x32_bf16 v[72:75], v[40:43], a[172:175], v[72:75]
    v_add_f32 v144, v144, v145
    s_mov_b64 exec, s[52:53]
    ds_write_b32 v204, v144 offset:4608
    s_mov_b64 exec, -1
    v_add_f32 v146, v68, v69
    v_add_f32 v7, v70, v71
    v_add_f32 v146, v146, v7
    s_nop 0
    v_add_f32 v147, v72, v73
    v_add_f32 v7, v74, v75
    v_add_f32 v147, v147, v7
    s_nop 1
    v_permlane16_swap_b32 v146, v147
    v_add_f32 v146, v146, v147
    ds_write_b32 v203, v146 offset:3584
    s_waitcnt lgkmcnt(0)
    s_barrier
    s_cmp_eq_u32 s5, 0
    s_cbranch_scc0 gf_65
    s_mov_b32 exec_lo, 0xffffffff
    s_mov_b32 exec_hi, 0x0
    ds_read_b128 v[152:155], v206 offset:4608
    ds_read_b128 v[156:159], v206 offset:4624
    ds_read_b128 v[144:147], v205 offset:3584
    ds_read_b128 v[148:151], v205 offset:3840
    s_lshl_b32 s61, s6, 6
    s_add_u32 s61, s61, s96
    s_waitcnt lgkmcnt(2)
    v_add_f32 v152, v152, v153
    v_add_f32 v154, v154, v155
    v_add_f32 v152, v152, v154
    v_add_f32 v156, v156, v157
    v_add_f32 v158, v158, v159
    v_add_f32 v156, v156, v158
    v_mul_f32 v153, 0x3b000000, v152
    v_mul_f32 v156, 0x3b000000, v156
    v_fma_f32 v156, -v153, v153, v156
    v_max_f32 v156, 0, v156
    v_add_f32 v156, 0x3727c5ac, v156
    v_rsq_f32 v154, v156
    s_waitcnt lgkmcnt(0)
    v_add_f32 v144, v144, v145
    v_add_f32 v146, v146, v147
    v_add_f32 v144, v144, v146
    v_add_f32 v148, v148, v149
    v_add_f32 v150, v150, v151
    v_add_f32 v148, v148, v150
    v_fma_f32 v144, -v153, v171, v144
    v_fma_f32 v148, -v153, v172, v148
    v_mul_f32 v145, 0xbfb8aa3b, v154
    v_mul_f32 v144, v144, v145
    v_exp_f32 v144, v144
    v_mul_f32 v148, v148, v154
    v_add_f32 v144, 1.0, v144
    v_rcp_f32 v144, v144
    s_nop 0
    v_mul_f32 v144, v144, v148
    s_nop 1
    v_mov_b32_dpp v145, v144 quad_perm:[1,0,3,2] row_mask:0xf bank_mask:0xf
    v_cvt_pk_bf16_f32 v144, v144, v145
    v_min_u32 v144, 0xfffffffe, v144
    s_mov_b32 exec_lo, 0x55555555
    s_mov_b32 exec_hi, 0x0
    s_cmp_eq_u32 s46, 0
    s_cbranch_scc1 stg_66
    buffer_store_dword v144, v209, s[8:11], s61 offen
std_67:
    s_mov_b64 exec, -1
gf_65:
nog_60:
    s_cmp_eq_u32 s7, 1
    s_cbranch_scc1 L_fin
L_q2s2:
    s_cmp_lt_u32 s4, 16
    s_cbranch_scc1 wo_68
    s_lshl_b32 s61, s3, 11
    s_add_u32 s61, s61, 131072
    v_lshlrev_b32 v4, 7, v1
    s_mov_b64 exec, 0xffff
    buffer_load_dword v132, v4, s[8:11], s61 offen sc1
    s_mov_b64 exec, -1
    s_add_u32 s61, s67, 278528
    v_and_b32 v4, 31, v1
    v_lshlrev_b32 v4, 7, v4
    v_lshrrev_b32 v5, 5, v1
    v_lshl_add_u32 v4, v5, 14, v4
    buffer_load_dword v132, v4, s[8:11], s61 offen sc1
    buffer_load_dword v132, v195, s[8:11], s61 offen sc1
    buffer_load_dword v132, v196, s[8:11], s61 offen sc1
wo_68:
    s_add_u32 s60, s65, 1024
    s_add_u32 s62, s44, 9
    v_lshlrev_b32 v4, 2, v1
    s_mov_b64 exec, 0xffff
db_69:
    buffer_load_dword v5, v4, s[8:11], s60 offen sc1
    s_waitcnt vmcnt(0)
    v_cmp_ne_u32 vcc, s62, v5
    s_cbranch_vccz dbok_70
    s_sub_u32 s47, s47, 1
    s_cbranch_scc0 db_69
    s_branch L_abort
dbok_70:
    s_mov_b64 exec, -1
    s_mov_b32 s63, 950272
    s_mov_b32 m0, s58
xp_71:
    s_nop 0
    buffer_load_dwordx4 v189, s[8:11], s63 offen offset:0 sc1 lds
    buffer_load_dwordx4 v189, s[8:11], s63 offen offset:1024 sc1 lds
    buffer_load_dwordx4 v189, s[8:11], s63 offen offset:2048 sc1 lds
    buffer_load_dwordx4 v189, s[8:11], s63 offen offset:3072 sc1 lds
    s_waitcnt vmcnt(3)
    ds_read_b128 v[36:39], v190 offset:0
    s_waitcnt vmcnt(2)
    ds_read_b128 v[40:43], v190 offset:1024
    s_waitcnt vmcnt(1)
    ds_read_b128 v[44:47], v190 offset:2048
    s_waitcnt vmcnt(0)
    ds_read_b128 v[48:51], v190 offset:3072
    s_waitcnt lgkmcnt(3)
    v_max3_u32 v4, v36, v37, v38
    s_waitcnt lgkmcnt(2)
    v_max3_u32 v4, v4, v39, v40
    v_max3_u32 v4, v4, v41, v42
    s_waitcnt lgkmcnt(1)
    v_max3_u32 v4, v4, v43, v44
    v_max3_u32 v4, v4, v45, v46
    s_waitcnt lgkmcnt(0)
    v_max3_u32 v4, v4, v47, v48
    v_max3_u32 v4, v4, v49, v50
    v_max_u32 v4, v4, v51
    v_cmp_eq_u32 vcc, -1, v4
    s_cbranch_vccz xok_72
    s_sub_u32 s47, s47, 1
    s_cbranch_scc0 xp_71
    s_branch L_abort
xok_72:
    v_mfma_f32_16x16x32_bf16 v[76:79], v[36:39], v[36:39], 0
    v_mfma_f32_16x16x32_bf16 v[76:79], v[40:43], v[40:43], v[76:79]
    v_mfma_f32_16x16x32_bf16 v[76:79], v[44:47], v[44:47], v[76:79]
    v_mfma_f32_16x16x32_bf16 v[76:79], v[48:51], v[48:51], v[76:79]
    v_mfma_f32_16x16x32_bf16 v[80:83], v[36:39], v[8:11], 0
    v_mfma_f32_16x16x32_bf16 v[80:83], v[40:43], v[8:11], v[80:83]
    v_mfma_f32_16x16x32_bf16 v[80:83], v[44:47], v[8:11], v[80:83]
    v_mfma_f32_16x16x32_bf16 v[80:83], v[48:51], v[8:11], v[80:83]
    v_mfma_f32_16x16x32_bf16 v[68:71], v[36:39], a[128:131], 0
    s_nop 2
    v_add_f32 v144, v76, v77
    v_add_f32 v7, v78, v79
    v_mfma_f32_16x16x32_bf16 v[68:71], v[40:43], a[132:135], v[68:71]
    v_add_f32 v144, v144, v7
    v_cndmask_b32 v144, 0, v144, s[48:49]
    v_mfma_f32_16x16x32_bf16 v[68:71], v[44:47], a[136:139], v[68:71]
    s_nop 0
    v_add_f32_dpp v144, v144, v144 row_ror:8 row_mask:0xf bank_mask:0xf
    s_nop 1
    v_add_f32_dpp v144, v144, v144 row_ror:4 row_mask:0xf bank_mask:0xf
    v_mfma_f32_16x16x32_bf16 v[68:71], v[48:51], a[140:143], v[68:71]
    s_nop 0
    v_add_f32_dpp v144, v144, v144 row_ror:2 row_mask:0xf bank_mask:0xf
    s_nop 1
    v_add_f32_dpp v144, v144, v144 row_ror:1 row_mask:0xf bank_mask:0xf
    v_add_f32 v145, v80, v81
    v_add_f32 v7, v82, v83
    v_add_f32 v145, v145, v7
    v_cndmask_b32 v144, v145, v144, s[54:55]
    v_add_f32 v146, v68, v69
    v_add_f32 v7, v70, v71
    v_add_f32 v146, v146, v7
    s_nop 1
    v_permlane16_swap_b32 v146, v144
    v_add_f32 v144, v144, v146
    ds_write_b32 v203, v144 offset:2560
    s_waitcnt lgkmcnt(0)
    s_barrier
    s_cmp_eq_u32 s5, 0
    s_cbranch_scc0 qf_73
    s_mov_b32 exec_lo, 0xffffffff
    s_mov_b32 exec_hi, 0x0
    ds_read_b128 v[144:147], v205 offset:2560
    ds_read_b128 v[148:151], v207 offset:2560
    ds_read_b128 v[152:155], v207 offset:2576
    s_waitcnt lgkmcnt(0)
    v_add_f32 v148, v148, v149
    v_add_f32 v150, v150, v151
    v_add_f32 v148, v148, v150
    v_add_f32 v152, v152, v153
    v_add_f32 v154, v154, v155
    v_add_f32 v152, v152, v154
    v_add_f32 v144, v144, v145
    v_add_f32 v146, v146, v147
    v_add_f32 v144, v144, v146
    v_mul_f32 v149, 0x3b000000, v148
    v_mul_f32 v152, 0x3b000000, v152
    v_fma_f32 v152, -v149, v149, v152
    v_max_f32 v152, 0, v152
    v_add_f32 v152, 0x3727c5ac, v152
    v_rsq_f32 v150, v152
    v_fma_f32 v144, -v149, v170, v144
    v_mul_f32 v144, v144, v150
    s_nop 1
    v_mov_b32_dpp v145, v144 quad_perm:[1,0,3,2] row_mask:0xf bank_mask:0xf
    v_cvt_pk_bf16_f32 v146, v144, v145
    v_min_u32 v146, 0xfffffffe, v146
    s_mov_b32 exec_lo, 0x55555555
    s_mov_b32 exec_hi, 0x0
    s_cmp_eq_u32 s46, 0
    s_cbranch_scc1 stg_74
    buffer_store_dword v146, v191, s[8:11], s97 offen
std_75:
    s_mov_b64 exec, -1
qf_73:
    s_mov_b64 exec, s[50:51]
qp_76:
    buffer_load_dwordx4 v[12:15], v197, s[8:11], s98 offen offset:0 sc1
    buffer_load_dwordx4 v[16:19], v197, s[8:11], s98 offen offset:256 sc1
    buffer_load_dwordx4 v[20:23], v197, s[8:11], s98 offen offset:512 sc1
    buffer_load_dwordx4 v[24:27], v197, s[8:11], s98 offen offset:768 sc1
    s_waitcnt vmcnt(0)
    v_max3_u32 v4, v12, v13, v14
    v_max3_u32 v4, v4, v15, v16
    v_max3_u32 v4, v4, v17, v18
    v_max3_u32 v4, v4, v19, v20
    v_max3_u32 v4, v4, v21, v22
    v_max3_u32 v4, v4, v23, v24
    v_max3_u32 v4, v4, v25, v26
    v_max_u32 v4, v4, v27
    v_cmp_eq_u32 vcc, -1, v4
    s_cbranch_vccz qok_77
    s_sub_u32 s47, s47, 1
    s_cbranch_scc0 qp_76
    s_branch L_abort
qok_77:
    s_mov_b64 exec, -1
    s_add_u32 s66, s66, 278528
    s_add_u32 s67, s67, 278528
    s_add_u32 s69, s69, 65536
    s_add_u32 s96, s96, 8192
    s_mov_b32 s7, 1
    v_mfma_f32_16x16x32_bf16 v[84:87], a[0:3], v[12:15], 0
    v_mfma_f32_16x16x32_bf16 v[88:91], a[16:19], v[12:15], 0
    v_mfma_f32_16x16x32_bf16 v[92:95], a[32:35], v[12:15], 0
    v_mfma_f32_16x16x32_bf16 v[96:99], a[48:51], v[12:15], 0
    v_mfma_f32_16x16x32_bf16 v[84:87], a[4:7], v[16:19], v[84:87]
    v_mfma_f32_16x16x32_bf16 v[88:91], a[20:23], v[16:19], v[88:91]
    v_mfma_f32_16x16x32_bf16 v[92:95], a[36:39], v[16:19], v[92:95]
    v_mfma_f32_16x16x32_bf16 v[96:99], a[52:55], v[16:19], v[96:99]
    v_mfma_f32_16x16x32_bf16 v[84:87], a[8:11], v[20:23], v[84:87]
    v_mfma_f32_16x16x32_bf16 v[88:91], a[24:27], v[20:23], v[88:91]
    v_mfma_f32_16x16x32_bf16 v[92:95], a[40:43], v[20:23], v[92:95]
    v_mfma_f32_16x16x32_bf16 v[96:99], a[56:59], v[20:23], v[96:99]
    v_mfma_f32_16x16x32_bf16 v[84:87], a[12:15], v[24:27], v[84:87]
    v_mfma_f32_16x16x32_bf16 v[88:91], a[28:31], v[24:27], v[88:91]
    v_mfma_f32_16x16x32_bf16 v[92:95], a[44:47], v[24:27], v[92:95]
    v_mfma_f32_16x16x32_bf16 v[96:99], a[60:63], v[24:27], v[96:99]
    s_nop 5
    v_mov_b32_dpp v84, v88 row_shr:4 row_mask:0xf bank_mask:0x2
    v_mov_b32_dpp v85, v89 row_shr:4 row_mask:0xf bank_mask:0x2
    v_mov_b32_dpp v86, v90 row_shr:4 row_mask:0xf bank_mask:0x2
    v_mov_b32_dpp v87, v91 row_shr:4 row_mask:0xf bank_mask:0x2
    v_mov_b32_dpp v84, v92 row_shr:8 row_mask:0xf bank_mask:0x4
    v_mov_b32_dpp v85, v93 row_shr:8 row_mask:0xf bank_mask:0x4
    v_mov_b32_dpp v86, v94 row_shr:8 row_mask:0xf bank_mask:0x4
    v_mov_b32_dpp v87, v95 row_shr:8 row_mask:0xf bank_mask:0x4
    v_mov_b32_dpp v84, v96 row_shr:12 row_mask:0xf bank_mask:0x8
    v_mov_b32_dpp v85, v97 row_shr:12 row_mask:0xf bank_mask:0x8
    v_mov_b32_dpp v86, v98 row_shr:12 row_mask:0xf bank_mask:0x8
    v_mov_b32_dpp v87, v99 row_shr:12 row_mask:0xf bank_mask:0x8
    v_max3_f32 v144, v84, v85, v86
    v_max_f32 v144, v144, v87
    s_nop 1
    v_max_f32_dpp v144, v144, v144 row_ror:8 row_mask:0xf bank_mask:0xf
    s_nop 1
    v_max_f32_dpp v144, v144, v144 row_ror:4 row_mask:0xf bank_mask:0xf
    v_mov_b32 v4, v144
    s_nop 1
    v_permlane32_swap_b32 v144, v4
    v_max_f32 v144, v144, v4
    v_mov_b32 v4, v144
    s_nop 1
    v_permlane16_swap_b32 v144, v4
    v_max_f32 v144, v144, v4
    s_mov_b64 exec, 15
    ds_write_b32 v202, v144
    s_mov_b64 exec, -1
    s_waitcnt lgkmcnt(0)
    s_barrier
    ds_read_b128 v[148:151], v201
    s_mov_b32 s61, 0x3e0293ee
    s_waitcnt lgkmcnt(0)
    v_max3_f32 v144, v148, v149, v150
    v_max_f32 v144, v144, v151
    v_mul_f32 v184, s61, v144
    v_fma_f32 v84, v84, s61, -v184
    v_fma_f32 v85, v85, s61, -v184
    v_fma_f32 v86, v86, s61, -v184
    v_fma_f32 v87, v87, s61, -v184
    v_exp_f32 v84, v84
    v_exp_f32 v85, v85
    v_exp_f32 v86, v86
    v_exp_f32 v87, v87
    v_cvt_pk_bf16_f32 v146, v84, v85
    v_cvt_pk_bf16_f32 v147, v86, v87
    ds_write_b64 v199, v[146:147]
    v_add_f32 v144, v84, v85
    v_add_f32 v145, v86, v87
    v_add_f32 v144, v144, v145
    s_nop 1
    v_add_f32_dpp v144, v144, v144 row_ror:8 row_mask:0xf bank_mask:0xf
    s_nop 1
    v_add_f32_dpp v144, v144, v144 row_ror:4 row_mask:0xf bank_mask:0xf
    v_mov_b32 v4, v144
    s_nop 1
    v_permlane32_swap_b32 v144, v4
    v_add_f32 v144, v144, v4
    v_mov_b32 v4, v144
    s_nop 1
    v_permlane16_swap_b32 v144, v4
    v_add_f32 v144, v144, v4
    s_mov_b64 exec, 15
    ds_write_b32 v202, v144 offset:64
    s_mov_b64 exec, -1
    s_waitcnt lgkmcnt(0)
    s_barrier
    ds_read_b128 v[100:103], v200 offset:0
    ds_read_b128 v[104:107], v200 offset:256
    ds_read_b128 v[108:111], v200 offset:512
    ds_read_b128 v[112:115], v200 offset:768
    ds_read_b128 v[116:119], v200 offset:1024
    ds_read_b128 v[120:123], v200 offset:1280
    ds_read_b128 v[124:127], v200 offset:1536
    ds_read_b128 v[128:131], v200 offset:1792
    s_cmp_eq_u32 s5, 3
    s_cbranch_scc1 s3_78
    s_waitcnt lgkmcnt(7)
    v_mfma_f32_16x16x32_bf16 v[68:71], a[64:67], v[100:103], 0
    v_mfma_f32_16x16x32_bf16 v[72:75], a[68:71], v[100:103], 0
    s_waitcnt lgkmcnt(6)
    v_mfma_f32_16x16x32_bf16 v[68:71], a[72:75], v[104:107], v[68:71]
    v_mfma_f32_16x16x32_bf16 v[72:75], a[76:79], v[104:107], v[72:75]
    s_waitcnt lgkmcnt(5)
    v_mfma_f32_16x16x32_bf16 v[68:71], a[80:83], v[108:111], v[68:71]
    v_mfma_f32_16x16x32_bf16 v[72:75], a[84:87], v[108:111], v[72:75]
    s_waitcnt lgkmcnt(4)
    v_mfma_f32_16x16x32_bf16 v[68:71], a[88:91], v[112:115], v[68:71]
    v_mfma_f32_16x16x32_bf16 v[72:75], a[92:95], v[112:115], v[72:75]
    s_waitcnt lgkmcnt(3)
    v_mfma_f32_16x16x32_bf16 v[68:71], a[96:99], v[116:119], v[68:71]
    v_mfma_f32_16x16x32_bf16 v[72:75], a[100:103], v[116:119], v[72:75]
    s_waitcnt lgkmcnt(2)
    v_mfma_f32_16x16x32_bf16 v[68:71], a[104:107], v[120:123], v[68:71]
    v_mfma_f32_16x16x32_bf16 v[72:75], a[108:111], v[120:123], v[72:75]
    s_waitcnt lgkmcnt(1)
    v_mfma_f32_16x16x32_bf16 v[68:71], a[112:115], v[124:127], v[68:71]
    v_mfma_f32_16x16x32_bf16 v[72:75], a[116:119], v[124:127], v[72:75]
    s_waitcnt lgkmcnt(0)
    v_mfma_f32_16x16x32_bf16 v[68:71], a[120:123], v[128:131], v[68:71]
    v_mfma_f32_16x16x32_bf16 v[72:75], a[124:127], v[128:131], v[72:75]
    s_branch s4_79
s3_78:
    ds_read_b128 v[148:151], v201 offset:64
    s_add_u32 s61, s44, s7
    s_add_u32 s61, s61, 1
    v_mov_b32 v186, s61
    s_waitcnt lgkmcnt(8)
    v_mfma_f32_16x16x32_bf16 v[68:71], a[64:67], v[100:103], 0
    v_mfma_f32_16x16x32_bf16 v[72:75], a[68:71], v[100:103], 0
    s_waitcnt lgkmcnt(7)
    v_mfma_f32_16x16x32_bf16 v[68:71], a[72:75], v[104:107], v[68:71]
    v_mfma_f32_16x16x32_bf16 v[72:75], a[76:79], v[104:107], v[72:75]
    s_waitcnt lgkmcnt(6)
    v_mfma_f32_16x16x32_bf16 v[68:71], a[80:83], v[108:111], v[68:71]
    v_mfma_f32_16x16x32_bf16 v[72:75], a[84:87], v[108:111], v[72:75]
    s_waitcnt lgkmcnt(5)
    v_mfma_f32_16x16x32_bf16 v[68:71], a[88:91], v[112:115], v[68:71]
    v_mfma_f32_16x16x32_bf16 v[72:75], a[92:95], v[112:115], v[72:75]
    s_waitcnt lgkmcnt(0)
    v_add_f32 v148, v148, v149
    v_add_f32 v150, v150, v151
    v_add_f32 v148, v148, v150
    v_mov_b32 v185, v148
    s_mov_b64 exec, 15
    s_cmp_eq_u32 s46, 0
    s_cbranch_scc1 stg_80
    buffer_store_dwordx4 v[184:187], v212, s[8:11], s66 offen
std_81:
    s_mov_b64 exec, -1
    s_nop 0
    v_mfma_f32_16x16x32_bf16 v[68:71], a[96:99], v[116:119], v[68:71]
    v_mfma_f32_16x16x32_bf16 v[72:75], a[100:103], v[116:119], v[72:75]
    v_mfma_f32_16x16x32_bf16 v[68:71], a[104:107], v[120:123], v[68:71]
    v_mfma_f32_16x16x32_bf16 v[72:75], a[108:111], v[120:123], v[72:75]
    v_mfma_f32_16x16x32_bf16 v[68:71], a[112:115], v[124:127], v[68:71]
    v_mfma_f32_16x16x32_bf16 v[72:75], a[116:119], v[124:127], v[72:75]
    v_mfma_f32_16x16x32_bf16 v[68:71], a[120:123], v[128:131], v[68:71]
    v_mfma_f32_16x16x32_bf16 v[72:75], a[124:127], v[128:131], v[72:75]
s4_79:
    s_nop 6
    v_cvt_pk_bf16_f32 v144, v68, v69
    v_cvt_pk_bf16_f32 v145, v70, v71
    v_cvt_pk_bf16_f32 v146, v72, v73
    v_cvt_pk_bf16_f32 v147, v74, v75
    v_min_u32 v144, 0xfffffffe, v144
    v_min_u32 v145, 0xfffffffe, v145
    v_min_u32 v146, 0xfffffffe, v146
    v_min_u32 v147, 0xfffffffe, v147
    s_mov_b64 exec, s[50:51]
    s_cmp_eq_u32 s46, 0
    s_cbranch_scc1 stg_82
    buffer_store_dwordx4 v[144:147], v211, s[8:11], s66 offen
std_83:
    s_mov_b64 exec, -1
    s_cmp_lt_u32 s4, 16
    s_cbranch_scc1 L_loopA
    s_branch L_loopB
L_finalA:
    s_cmp_ge_u32 s6, 2
    s_cbranch_scc1 L_fin
    s_cmp_eq_u32 s5, 0
    s_cbranch_scc0 L_fin
    s_lshl_b32 s61, s3, 1
    s_add_u32 s61, s61, s6
    s_lshl_b32 s62, s61, 10
    s_xor_b32 s63, s62, 0x2000
    s_add_u32 s63, s63, 16384
    s_lshr_b32 s60, s99, 2
    s_lshr_b32 s100, s61, 3
    s_cmp_eq_u32 s60, s100
    s_cselect_b32 s62, s62, s63
    s_add_u32 s62, s62, 1015808
    v_lshlrev_b32 v4, 3, v3
    v_add_u32 v4, 0, v4
    v_sub_u32 v4, v4, v2
    v_mov_b32 v100, 0
    v_cmp_eq_u32 vcc, 0, v4
    v_mov_b32 v5, 0x3f80
    s_nop 0
    v_cndmask_b32 v100, v100, v5, vcc
    v_cmp_eq_u32 vcc, -1, v4
    v_mov_b32 v5, 0x3f800000
    s_nop 0
    v_cndmask_b32 v100, v100, v5, vcc
    v_lshlrev_b32 v4, 3, v3
    v_add_u32 v4, 2, v4
    v_sub_u32 v4, v4, v2
    v_mov_b32 v101, 0
    v_cmp_eq_u32 vcc, 0, v4
    v_mov_b32 v5, 0x3f80
    s_nop 0
    v_cndmask_b32 v101, v101, v5, vcc
    v_cmp_eq_u32 vcc, -1, v4
    v_mov_b32 v5, 0x3f800000
    s_nop 0
    v_cndmask_b32 v101, v101, v5, vcc
    v_lshlrev_b32 v4, 3, v3
    v_add_u32 v4, 4, v4
    v_sub_u32 v4, v4, v2
    v_mov_b32 v102, 0
    v_cmp_eq_u32 vcc, 0, v4
    v_mov_b32 v5, 0x3f80
    s_nop 0
    v_cndmask_b32 v102, v102, v5, vcc
    v_cmp_eq_u32 vcc, -1, v4
    v_mov_b32 v5, 0x3f800000
    s_nop 0
    v_cndmask_b32 v102, v102, v5, vcc
    v_lshlrev_b32 v4, 3, v3
    v_add_u32 v4, 6, v4
    v_sub_u32 v4, v4, v2
    v_mov_b32 v103, 0
    v_cmp_eq_u32 vcc, 0, v4
    v_mov_b32 v5, 0x3f80
    s_nop 0
    v_cndmask_b32 v103, v103, v5, vcc
    v_cmp_eq_u32 vcc, -1, v4
    v_mov_b32 v5, 0x3f800000
    s_nop 0
    v_cndmask_b32 v103, v103, v5, vcc
    v_lshlrev_b32 v4, 3, v3
    v_add_u32 v4, -16, v4
    v_sub_u32 v4, v4, v2
    v_mov_b32 v104, 0
    v_cmp_eq_u32 vcc, 0, v4
    v_mov_b32 v5, 0x3f80
    s_nop 0
    v_cndmask_b32 v104, v104, v5, vcc
    v_cmp_eq_u32 vcc, -1, v4
    v_mov_b32 v5, 0x3f800000
    s_nop 0
    v_cndmask_b32 v104, v104, v5, vcc
    v_lshlrev_b32 v4, 3, v3
    v_add_u32 v4, -14, v4
    v_sub_u32 v4, v4, v2
    v_mov_b32 v105, 0
    v_cmp_eq_u32 vcc, 0, v4
    v_mov_b32 v5, 0x3f80
    s_nop 0
    v_cndmask_b32 v105, v105, v5, vcc
    v_cmp_eq_u32 vcc, -1, v4
    v_mov_b32 v5, 0x3f800000
    s_nop 0
    v_cndmask_b32 v105, v105, v5, vcc
    v_lshlrev_b32 v4, 3, v3
    v_add_u32 v4, -12, v4
    v_sub_u32 v4, v4, v2
    v_mov_b32 v106, 0
    v_cmp_eq_u32 vcc, 0, v4
    v_mov_b32 v5, 0x3f80
    s_nop 0
    v_cndmask_b32 v106, v106, v5, vcc
    v_cmp_eq_u32 vcc, -1, v4
    v_mov_b32 v5, 0x3f800000
    s_nop 0
    v_cndmask_b32 v106, v106, v5, vcc
    v_lshlrev_b32 v4, 3, v3
    v_add_u32 v4, -10, v4
    v_sub_u32 v4, v4, v2
    v_mov_b32 v107, 0
    v_cmp_eq_u32 vcc, 0, v4
    v_mov_b32 v5, 0x3f80
    s_nop 0
    v_cndmask_b32 v107, v107, v5, vcc
    v_cmp_eq_u32 vcc, -1, v4
    v_mov_b32 v5, 0x3f800000
    s_nop 0
    v_cndmask_b32 v107, v107, v5, vcc
    v_lshrrev_b32 v6, 1, v3
    v_lshlrev_b32 v6, 10, v6
    v_and_b32 v5, 1, v3
    v_lshl_add_u32 v6, v5, 5, v6
    v_lshl_add_u32 v6, v2, 1, v6
    s_lshl_b32 s61, s61, 6
    s_mov_b32 s50, s62
    s_mov_b32 s51, s61
    s_mov_b32 s62, s50
    s_mov_b32 s61, s51
fp_84:
    buffer_load_dwordx4 v[28:31], v188, s[8:11], s62 offen sc1
    s_waitcnt vmcnt(0)
    v_max3_u32 v4, v28, v29, v30
    v_max_u32 v4, v4, v31
    v_cmp_eq_u32 vcc, -1, v4
    s_cbranch_vccz fok_85
    s_sub_u32 s47, s47, 1
    s_cbranch_scc0 fp_84
    s_branch L_abort
fok_85:
    v_mfma_f32_16x16x32_bf16 v[68:71], v[28:31], v[100:103], 0
    v_mfma_f32_16x16x32_bf16 v[72:75], v[28:31], v[104:107], 0
    s_nop 6
    v_add_f32 v144, v68, v69
    v_add_f32 v7, v70, v71
    v_add_f32 v144, v144, v7
    v_add_f32 v145, v72, v73
    v_add_f32 v7, v74, v75
    v_add_f32 v145, v145, v7
    s_nop 1
    v_permlane16_swap_b32 v144, v145
    v_add_f32 v144, v144, v145
    v_cvt_pk_bf16_f32 v144, v144, v144
    buffer_store_short v144, v6, s[40:43], s61 offen
L_fin:
    s_waitcnt vmcnt(0)
    s_endpgm
L_abort:
    s_mov_b64 exec, -1
    v_mov_b32 v4, 0
    v_mov_b32 v5, 0xdead
    s_load_dwordx2 s[100:101], s[0:1], 80
    s_waitcnt lgkmcnt(0)
    s_mov_b32 s60, s100
    s_and_b32 s61, s101, 0xffff
    s_mov_b32 s62, 256
    s_mov_b32 s63, 0x20000
    s_mov_b64 exec, 1
    buffer_store_dword v5, v4, s[60:63], 0 offen offset:4
    s_waitcnt vmcnt(0)
L_end:
    s_endpgm
stg_11:
    buffer_store_dwordx4 v[152:155], v192, s[8:11], s66 offen sc1
    s_branch std_12
stg_15:
    buffer_store_dwordx4 v[152:155], v192, s[8:11], s66 offen sc1
    s_branch std_16
stg_19:
    buffer_store_dwordx4 v[144:147], v211, s[8:11], s66 offen sc1
    s_branch std_20
stg_22:
    buffer_store_dwordx4 v[184:187], v212, s[8:11], s66 offen sc1
    s_branch std_23
stg_25:
    buffer_store_dwordx4 v[152:155], v192, s[8:11], s61 offen sc1
    s_branch std_26
stg_33:
    buffer_store_dword v5, v4, s[8:11], s64 offen sc1
    s_branch std_34
stg_46:
    buffer_store_dword v5, v4, s[8:11], s64 offen sc1
    s_branch std_47
stg_49:
    buffer_store_dwordx4 v[144:147], v211, s[8:11], s66 offen sc1
    s_branch std_50
stg_52:
    buffer_store_dwordx4 v[184:187], v212, s[8:11], s66 offen sc1
    s_branch std_53
stg_55:
    buffer_store_dwordx4 v[152:155], v192, s[8:11], s61 offen sc1
    s_branch std_56
stg_66:
    buffer_store_dword v144, v209, s[8:11], s61 offen sc1
    s_branch std_67
stg_74:
    buffer_store_dword v146, v191, s[8:11], s97 offen sc1
    s_branch std_75
stg_80:
    buffer_store_dwordx4 v[184:187], v212, s[8:11], s66 offen sc1
    s_branch std_81
stg_82:
    buffer_store_dwordx4 v[144:147], v211, s[8:11], s66 offen sc1
    s_branch std_83
L_codeend:
    s_endpgm
.section .rodata,"a"
.p2align 6
.amdhsa_kernel interleave_layers__sliding_block_cached__glu_gated_glu__decode_kernel
  .amdhsa_next_free_vgpr 448
  .amdhsa_next_free_sgpr 102
  .amdhsa_accum_offset 256
  .amdhsa_group_segment_fixed_size 0
  .amdhsa_kernarg_size 96
  .amdhsa_user_sgpr_count 2
  .amdhsa_user_sgpr_kernarg_segment_ptr 1
  .amdhsa_system_sgpr_workgroup_id_x 1
.end_amdhsa_kernel
```
